```python
import torch

def _softmax(x, axis=-1):
    return torch.softmax(x, dim=axis)
def _gelu(x):
    return torch.nn.functional.gelu(x, approximate="tanh")
def _silu(x):
    return torch.nn.functional.silu(x)
def _sigmoid(x):
    return torch.sigmoid(x)
def _layernorm(x, axis=-1, eps=1e-5):
    m = x.mean(dim=axis, keepdim=True)
    v = x.var(dim=axis, keepdim=True, unbiased=False)
    return (x - m) / torch.sqrt(v + eps)
def _scatter_add(tgt, idx, src, axis=0):
    return tgt.clone().index_add_(axis, idx, src)
def _segment_sum(src, seg, n):
    out = torch.zeros((n,) + src.shape[1:], dtype=src.dtype)
    return out.index_add_(0, seg, src)
def _pad(x, pw):
    flat = tuple(v for pair in reversed(pw) for v in pair)
    return torch.nn.functional.pad(x, flat)

kernel_name = 'parallel_sum__gqa_block_cached__mixer_channel_mlp__decode'

def setup_inputs():

    _w = (lambda a: (lambda t: t.to(torch.bfloat16) if t.is_floating_point() else t)(torch.as_tensor(a)))
    def _A_setup():
        B, Sq, D = 8, 1, 448
        Hq, Hkv, Sk, Dh = 16, 8, 4096, 256
        assert Hq % Hkv == 0, (Hq, Hkv)
        return {
            "x": _w((lambda *s: torch.randn(*s, dtype=torch.bfloat16) * 0.05)(B, Sq, D)),
            "k_cache": _w((lambda *s: torch.randn(*s, dtype=torch.bfloat16) * 3.2)(B, Hkv, Sk, Dh)),
            "v_cache": _w((lambda *s: torch.randn(*s, dtype=torch.bfloat16) * 0.4)(B, Hkv, Sk, Dh)),
            "wq": _w((lambda *s: torch.randn(*s, dtype=torch.bfloat16) * 3.2)(D, Hq * Dh) * (D ** -0.5)),
            "wo": _w((lambda *s: torch.randn(*s, dtype=torch.bfloat16) * 0.4)(Hq * Dh, D) * ((Hq * Dh) ** -0.5)),
        }
    _A_in = _A_setup()

    def _B_setup():
        B, S, D, F = 8, 1, 448, 1792
        return {
            "x": _w((lambda *s: torch.randn(*s, dtype=torch.bfloat16) * 0.05)(B, S, D)),
            "w1": _w((lambda *s: torch.randn(*s, dtype=torch.bfloat16) * 3.2)(D, F) * (D ** -0.5)),
            "b1": _w((lambda *s: torch.randn(*s, dtype=torch.bfloat16) * 0.8)(F)),
            "w2": _w((lambda *s: torch.randn(*s, dtype=torch.bfloat16) * 0.1)(F, D) * (F ** -0.5)),
            "b2": _w((lambda *s: torch.randn(*s, dtype=torch.bfloat16) * 0.1)(D)),
        }
    _B_in = _B_setup()

    return {
        "A_x": _A_in["x"],
        "A_k_cache": _A_in["k_cache"],
        "A_v_cache": _A_in["v_cache"],
        "A_wq": _A_in["wq"],
        "A_wo": _A_in["wo"],
        "B_x": _B_in["x"],
        "B_w1": _B_in["w1"],
        "B_b1": _B_in["b1"],
        "B_w2": _B_in["w2"],
        "B_b2": _B_in["b2"],
    }

def reference(A_x, A_k_cache, A_v_cache, A_wq, A_wo, B_x, B_w1, B_b1, B_w2, B_b2):
    def _A_ref(x, k_cache, v_cache, wq, wo):
        B, Sq, D = x.shape
        Hq, Dh = 16, 256
        Hkv = k_cache.shape[1]
        rep = Hq // Hkv
        q = (lambda x, *d: x.permute(*d))((x @ wq).reshape(B, Sq, Hq, Dh), 0, 2, 1, 3)
        k = (lambda x, n, axis: torch.repeat_interleave(x, n, dim=axis))(k_cache, rep, axis=1)
        v = (lambda x, n, axis: torch.repeat_interleave(x, n, dim=axis))(v_cache, rep, axis=1)
        scores = torch.einsum("bhqd,bhkd->bhqk", q, k) * (Dh ** -0.5)
        p = _softmax(scores, axis=-1)
        o = torch.einsum("bhqk,bhkd->bhqd", p, v)
        return (lambda x, *d: x.permute(*d))(o, 0, 2, 1, 3).reshape(B, Sq, Hq * Dh) @ wo

    def _B_ref(x, w1, b1, w2, b2):
        y = _layernorm(x, axis=-1)
        h = _gelu(torch.einsum("bsd,df->bsf", y, w1) + b1)
        return torch.einsum("bsf,fd->bsd", h, w2) + b2

    x = A_x
    xn = _layernorm(x, axis=-1)
    return x + _A_ref(xn, A_k_cache, A_v_cache, A_wq, A_wo) + _B_ref(xn, B_w1, B_b1, B_w2, B_b2)
```

```asm
; @launch grid=(256,1,1) block=(384,1,1) lds=162048
.amdgcn_target "amdgcn-amd-amdhsa--gfx950"
.text
.globl parallel_sum__gqa_block_cached__mixer_channel_mlp__decode_kernel
.p2align 8
.type parallel_sum__gqa_block_cached__mixer_channel_mlp__decode_kernel,@function
parallel_sum__gqa_block_cached__mixer_channel_mlp__decode_kernel:
    s_cmp_ge_u32 s2, 256
    s_cbranch_scc1 L_end
    s_load_dwordx4 s[4:7], s[0:1], 8
    v_lshrrev_b32 v1, 6, v0
    v_and_b32 v0, 63, v0
    v_readfirstlane_b32 s3, v1
    s_and_b32 s33, s2, 7
    s_lshr_b32 s19, s2, 3
    s_and_b32 s21, s19, 7
    s_lshr_b32 s22, s19, 3
    s_sub_u32 s32, s19, 16
    s_and_b32 s32, s32, 31
    s_xor_b32 s101, s22, 3
    s_lshl_b32 s20, s22, 2
    s_lshr_b32 s20, 25904, s20
    s_xor_b32 s20, s20, s33
    s_and_b32 s20, s20, 7
    s_cmp_eq_u32 s3, 5
    s_cbranch_scc1 L_helper
    s_cmp_lg_u32 s3, 0
    s_cbranch_scc1 L_consumer
    s_setprio 3
    v_lshrrev_b32 v10, 5, v0
    v_and_b32 v11, 31, v0
    v_lshlrev_b32 v12, 9, v10
    v_add_u32 v13, 0, v10
    v_xor_b32 v13, v13, v11
    v_lshl_add_u32 v2, v13, 4, v12
    v_add_u32 v13, 2, v10
    v_xor_b32 v13, v13, v11
    v_lshl_add_u32 v3, v13, 4, v12
    v_add_u32 v13, 4, v10
    v_xor_b32 v13, v13, v11
    v_lshl_add_u32 v4, v13, 4, v12
    v_add_u32 v13, 6, v10
    v_xor_b32 v13, v13, v11
    v_lshl_add_u32 v5, v13, 4, v12
    v_add_u32 v13, 8, v10
    v_xor_b32 v13, v13, v11
    v_lshl_add_u32 v6, v13, 4, v12
    v_add_u32 v13, 10, v10
    v_xor_b32 v13, v13, v11
    v_lshl_add_u32 v7, v13, 4, v12
    v_add_u32 v13, 12, v10
    v_xor_b32 v13, v13, v11
    v_lshl_add_u32 v8, v13, 4, v12
    v_add_u32 v13, 14, v10
    v_xor_b32 v13, v13, v11
    v_lshl_add_u32 v9, v13, 4, v12
    s_lshl_b32 s17, s21, 3
    s_add_u32 s17, s17, s20
    s_lshl_b32 s17, s17, 2
    s_add_u32 s17, s17, s22
    s_lshl_b32 s17, s17, 19
    s_mov_b32 s10, 0x80000
    s_mov_b32 s11, 0x20000
    s_mov_b32 s12, 0
    s_mov_b32 s14, 0
    s_mov_b32 s18, 0x400000
    s_waitcnt lgkmcnt(0)
    s_add_u32 s8, s4, s17
    s_addc_u32 s9, s5, 0
    s_and_b32 s17, s17, 0xffe00000
    s_add_u32 s6, s6, s17
    s_addc_u32 s7, s7, 0
    s_add_u32 m0, s14, 0
    s_add_u32 s13, s12, 0
    buffer_load_dwordx4 v2, s[8:11], s13 offen offset:0 nt lds
    buffer_load_dwordx4 v3, s[8:11], s13 offen offset:1024 nt lds
    buffer_load_dwordx4 v4, s[8:11], s13 offen offset:2048 nt lds
    buffer_load_dwordx4 v5, s[8:11], s13 offen offset:3072 nt lds
    s_add_u32 m0, s14, 4096
    s_add_u32 s13, s12, 4096
    buffer_load_dwordx4 v6, s[8:11], s13 offen offset:0 nt lds
    buffer_load_dwordx4 v7, s[8:11], s13 offen offset:1024 nt lds
    buffer_load_dwordx4 v8, s[8:11], s13 offen offset:2048 nt lds
    buffer_load_dwordx4 v9, s[8:11], s13 offen offset:3072 nt lds
    v_mov_b32 v16, 0
    v_mov_b32 v17, 0
    v_mov_b32 v18, 0
    v_mov_b32 v19, 0
    v_mov_b32 v14, 131072
    v_lshl_add_u32 v13, v0, 4, v14
    ds_write_b128 v13, v[16:19]
    s_add_u32 m0, s14, 8192
    s_add_u32 s13, s12, 8192
    buffer_load_dwordx4 v2, s[8:11], s13 offen offset:0 nt lds
    buffer_load_dwordx4 v3, s[8:11], s13 offen offset:1024 nt lds
    buffer_load_dwordx4 v4, s[8:11], s13 offen offset:2048 nt lds
    buffer_load_dwordx4 v5, s[8:11], s13 offen offset:3072 nt lds
    s_add_u32 m0, s14, 12288
    s_add_u32 s13, s12, 12288
    buffer_load_dwordx4 v6, s[8:11], s13 offen offset:0 nt lds
    buffer_load_dwordx4 v7, s[8:11], s13 offen offset:1024 nt lds
    buffer_load_dwordx4 v8, s[8:11], s13 offen offset:2048 nt lds
    buffer_load_dwordx4 v9, s[8:11], s13 offen offset:3072 nt lds
    s_waitcnt lgkmcnt(0)
    s_barrier
    s_add_u32 m0, s14, 16384
    s_add_u32 s13, s12, 16384
    buffer_load_dwordx4 v2, s[8:11], s13 offen offset:0 nt lds
    buffer_load_dwordx4 v3, s[8:11], s13 offen offset:1024 nt lds
    buffer_load_dwordx4 v4, s[8:11], s13 offen offset:2048 nt lds
    buffer_load_dwordx4 v5, s[8:11], s13 offen offset:3072 nt lds
    s_add_u32 m0, s14, 20480
    s_add_u32 s13, s12, 20480
    buffer_load_dwordx4 v6, s[8:11], s13 offen offset:0 nt lds
    s_waitcnt vmcnt(20)
    buffer_load_dwordx4 v7, s[8:11], s13 offen offset:1024 nt lds
    s_waitcnt vmcnt(20)
    buffer_load_dwordx4 v8, s[8:11], s13 offen offset:2048 nt lds
    s_waitcnt vmcnt(20)
    buffer_load_dwordx4 v9, s[8:11], s13 offen offset:3072 nt lds
    s_add_u32 m0, s14, 24576
    s_add_u32 s13, s12, 24576
    s_waitcnt vmcnt(20)
    buffer_load_dwordx4 v2, s[8:11], s13 offen offset:0 nt lds
    s_waitcnt vmcnt(20)
    buffer_load_dwordx4 v3, s[8:11], s13 offen offset:1024 nt lds
    s_waitcnt vmcnt(20)
    buffer_load_dwordx4 v4, s[8:11], s13 offen offset:2048 nt lds
    s_waitcnt vmcnt(20)
    buffer_load_dwordx4 v5, s[8:11], s13 offen offset:3072 nt lds
    s_add_u32 m0, s14, 28672
    s_add_u32 s13, s12, 28672
    s_waitcnt vmcnt(20)
    v_mov_b32 v15, 1
    ds_write_b32 v14, v15 offset:0
    buffer_load_dwordx4 v6, s[8:11], s13 offen offset:0 nt lds
    s_waitcnt vmcnt(20)
    buffer_load_dwordx4 v7, s[8:11], s13 offen offset:1024 nt lds
    s_waitcnt vmcnt(20)
    buffer_load_dwordx4 v8, s[8:11], s13 offen offset:2048 nt lds
    s_waitcnt vmcnt(20)
    buffer_load_dwordx4 v9, s[8:11], s13 offen offset:3072 nt lds
    s_mov_b32 s15, 1
    v_mov_b32 v24, 0
L_ld_loop0:
    s_add_u32 s12, s12, 32768
    s_add_u32 s14, s14, 32768
    s_and_b32 s14, s14, 0x1ffff
    s_sub_u32 s16, s15, 3
L_ld_v0_0:
    s_waitcnt lgkmcnt(0)
    v_readfirstlane_b32 s17, v16
    s_nop 0
    s_cmp_ge_i32 s17, s16
    s_cbranch_scc1 L_ldok_1
L_ldrt_2:
    ds_read_b128 v[16:19], v14 offset:16
    s_sub_u32 s18, s18, 1
    s_cbranch_scc1 L_end
    s_waitcnt lgkmcnt(0)
    v_readfirstlane_b32 s17, v16
    s_nop 0
    s_cmp_ge_i32 s17, s16
    s_cbranch_scc0 L_ldrt_2
L_ldok_1:
    ds_read_b128 v[16:19], v14 offset:16
    s_add_u32 m0, s14, 0
    s_add_u32 s13, s12, 0
    s_waitcnt vmcnt(20)
    buffer_load_dwordx4 v2, s[8:11], s13 offen offset:0 nt lds
    s_waitcnt vmcnt(20)
    buffer_load_dwordx4 v3, s[8:11], s13 offen offset:1024 nt lds
    s_waitcnt vmcnt(20)
    buffer_load_dwordx4 v4, s[8:11], s13 offen offset:2048 nt lds
    s_waitcnt vmcnt(20)
    buffer_load_dwordx4 v5, s[8:11], s13 offen offset:3072 nt lds
    s_add_u32 m0, s14, 4096
    s_add_u32 s13, s12, 4096
    s_waitcnt vmcnt(20)
    s_lshl2_add_u32 s17, s15, -2
    v_mov_b32 v15, s17
    ds_write_b32 v14, v15 offset:0
    buffer_load_dwordx4 v6, s[8:11], s13 offen offset:0 nt lds
    s_waitcnt vmcnt(20)
    buffer_load_dwordx4 v7, s[8:11], s13 offen offset:1024 nt lds
    s_waitcnt vmcnt(20)
    buffer_load_dwordx4 v8, s[8:11], s13 offen offset:2048 nt lds
    s_waitcnt vmcnt(20)
    buffer_load_dwordx4 v9, s[8:11], s13 offen offset:3072 nt lds
    s_waitcnt lgkmcnt(0)
    v_readfirstlane_b32 s17, v17
    s_nop 0
    s_cmp_ge_i32 s17, s16
    s_cbranch_scc1 L_ldok_3
L_ldrt_4:
    ds_read_b128 v[16:19], v14 offset:16
    s_sub_u32 s18, s18, 1
    s_cbranch_scc1 L_end
    s_waitcnt lgkmcnt(0)
    v_readfirstlane_b32 s17, v17
    s_nop 0
    s_cmp_ge_i32 s17, s16
    s_cbranch_scc0 L_ldrt_4
L_ldok_3:
    ds_read_b128 v[16:19], v14 offset:16
    s_add_u32 m0, s14, 8192
    s_add_u32 s13, s12, 8192
    s_waitcnt vmcnt(20)
    buffer_load_dwordx4 v2, s[8:11], s13 offen offset:0 nt lds
    s_waitcnt vmcnt(20)
    buffer_load_dwordx4 v3, s[8:11], s13 offen offset:1024 nt lds
    s_waitcnt vmcnt(20)
    buffer_load_dwordx4 v4, s[8:11], s13 offen offset:2048 nt lds
    s_waitcnt vmcnt(20)
    buffer_load_dwordx4 v5, s[8:11], s13 offen offset:3072 nt lds
    s_add_u32 m0, s14, 12288
    s_add_u32 s13, s12, 12288
    s_waitcnt vmcnt(20)
    s_lshl2_add_u32 s17, s15, -1
    v_mov_b32 v15, s17
    ds_write_b32 v14, v15 offset:0
    buffer_load_dwordx4 v6, s[8:11], s13 offen offset:0 nt lds
    s_waitcnt vmcnt(20)
    buffer_load_dwordx4 v7, s[8:11], s13 offen offset:1024 nt lds
    s_waitcnt vmcnt(20)
    buffer_load_dwordx4 v8, s[8:11], s13 offen offset:2048 nt lds
    s_waitcnt vmcnt(20)
    buffer_load_dwordx4 v9, s[8:11], s13 offen offset:3072 nt lds
    s_waitcnt lgkmcnt(0)
    v_readfirstlane_b32 s17, v18
    s_nop 0
    s_cmp_ge_i32 s17, s16
    s_cbranch_scc1 L_ldok_5
L_ldrt_6:
    ds_read_b128 v[16:19], v14 offset:16
    s_sub_u32 s18, s18, 1
    s_cbranch_scc1 L_end
    s_waitcnt lgkmcnt(0)
    v_readfirstlane_b32 s17, v18
    s_nop 0
    s_cmp_ge_i32 s17, s16
    s_cbranch_scc0 L_ldrt_6
L_ldok_5:
    ds_read_b128 v[16:19], v14 offset:16
    s_add_u32 m0, s14, 16384
    s_add_u32 s13, s12, 16384
    s_waitcnt vmcnt(20)
    buffer_load_dwordx4 v2, s[8:11], s13 offen offset:0 nt lds
    s_waitcnt vmcnt(20)
    buffer_load_dwordx4 v3, s[8:11], s13 offen offset:1024 nt lds
    s_waitcnt vmcnt(20)
    buffer_load_dwordx4 v4, s[8:11], s13 offen offset:2048 nt lds
    s_waitcnt vmcnt(20)
    buffer_load_dwordx4 v5, s[8:11], s13 offen offset:3072 nt lds
    s_add_u32 m0, s14, 20480
    s_add_u32 s13, s12, 20480
    s_waitcnt vmcnt(20)
    s_lshl2_add_u32 s17, s15, 0
    v_mov_b32 v15, s17
    ds_write_b32 v14, v15 offset:0
    buffer_load_dwordx4 v6, s[8:11], s13 offen offset:0 nt lds
    s_waitcnt vmcnt(20)
    buffer_load_dwordx4 v7, s[8:11], s13 offen offset:1024 nt lds
    s_waitcnt vmcnt(20)
    buffer_load_dwordx4 v8, s[8:11], s13 offen offset:2048 nt lds
    s_waitcnt vmcnt(20)
    buffer_load_dwordx4 v9, s[8:11], s13 offen offset:3072 nt lds
    s_waitcnt lgkmcnt(0)
    v_readfirstlane_b32 s17, v19
    s_nop 0
    s_cmp_ge_i32 s17, s16
    s_cbranch_scc1 L_ldok_7
L_ldrt_8:
    ds_read_b128 v[16:19], v14 offset:16
    s_sub_u32 s18, s18, 1
    s_cbranch_scc1 L_end
    s_waitcnt lgkmcnt(0)
    v_readfirstlane_b32 s17, v19
    s_nop 0
    s_cmp_ge_i32 s17, s16
    s_cbranch_scc0 L_ldrt_8
L_ldok_7:
    ds_read_b128 v[16:19], v14 offset:16
    s_add_u32 m0, s14, 24576
    s_add_u32 s13, s12, 24576
    s_waitcnt vmcnt(20)
    buffer_load_dwordx4 v2, s[8:11], s13 offen offset:0 nt lds
    s_waitcnt vmcnt(20)
    buffer_load_dwordx4 v3, s[8:11], s13 offen offset:1024 nt lds
    s_waitcnt vmcnt(20)
    buffer_load_dwordx4 v4, s[8:11], s13 offen offset:2048 nt lds
    s_waitcnt vmcnt(20)
    buffer_load_dwordx4 v5, s[8:11], s13 offen offset:3072 nt lds
    s_add_u32 m0, s14, 28672
    s_add_u32 s13, s12, 28672
    s_waitcnt vmcnt(20)
    s_lshl2_add_u32 s17, s15, 1
    v_mov_b32 v15, s17
    ds_write_b32 v14, v15 offset:0
    buffer_load_dwordx4 v6, s[8:11], s13 offen offset:0 nt lds
    s_waitcnt vmcnt(20)
    buffer_load_dwordx4 v7, s[8:11], s13 offen offset:1024 nt lds
    s_waitcnt vmcnt(20)
    buffer_load_dwordx4 v8, s[8:11], s13 offen offset:2048 nt lds
    s_waitcnt vmcnt(20)
    buffer_load_dwordx4 v9, s[8:11], s13 offen offset:3072 nt lds
L_ld_e0:
    s_add_u32 s15, s15, 1
    s_cmp_lt_u32 s15, 16
    s_cbranch_scc1 L_ld_loop0
    s_mov_b32 s8, s6
    s_mov_b32 s9, s7
    s_mov_b32 s10, 0x200000
    s_lshl_b32 s12, s22, 19
    s_sub_u32 s12, s12, 32768
    v_lshlrev_b32 v2, 4, v0
    v_lshlrev_b32 v3, 4, v0
    v_lshlrev_b32 v4, 4, v0
    v_lshlrev_b32 v5, 4, v0
    v_lshlrev_b32 v6, 4, v0
    v_lshlrev_b32 v7, 4, v0
    v_lshlrev_b32 v8, 4, v0
    v_lshlrev_b32 v9, 4, v0
L_ld_loop1:
    s_add_u32 s12, s12, 32768
    s_add_u32 s14, s14, 32768
    s_and_b32 s14, s14, 0x1ffff
    s_sub_u32 s16, s15, 3
L_ld_v1_0:
    s_waitcnt lgkmcnt(0)
    v_readfirstlane_b32 s17, v16
    s_nop 0
    s_cmp_ge_i32 s17, s16
    s_cbranch_scc1 L_ldok_9
L_ldrt_10:
    ds_read_b128 v[16:19], v14 offset:16
    s_sub_u32 s18, s18, 1
    s_cbranch_scc1 L_end
    s_waitcnt lgkmcnt(0)
    v_readfirstlane_b32 s17, v16
    s_nop 0
    s_cmp_ge_i32 s17, s16
    s_cbranch_scc0 L_ldrt_10
L_ldok_9:
    ds_read_b128 v[16:19], v14 offset:16
    s_add_u32 m0, s14, 0
    s_add_u32 s13, s12, 0
    s_waitcnt vmcnt(21)
    buffer_load_dwordx4 v2, s[8:11], s13 offen offset:0 nt lds
    s_waitcnt vmcnt(21)
    buffer_load_dwordx4 v3, s[8:11], s13 offen offset:1024 nt lds
    s_waitcnt vmcnt(21)
    buffer_load_dwordx4 v4, s[8:11], s13 offen offset:2048 nt lds
    s_waitcnt vmcnt(21)
    buffer_load_dwordx4 v5, s[8:11], s13 offen offset:3072 nt lds
    s_add_u32 m0, s14, 4096
    s_add_u32 s13, s12, 4096
    s_waitcnt vmcnt(21)
    buffer_load_dwordx4 v6, s[8:11], s13 offen offset:0 nt lds
    s_waitcnt vmcnt(21)
    s_lshl2_add_u32 s17, s15, -2
    v_mov_b32 v15, s17
    ds_write_b32 v14, v15 offset:0
    buffer_load_dwordx4 v7, s[8:11], s13 offen offset:1024 nt lds
    s_waitcnt vmcnt(21)
    buffer_load_dwordx4 v8, s[8:11], s13 offen offset:2048 nt lds
    s_waitcnt vmcnt(21)
    buffer_load_dwordx4 v9, s[8:11], s13 offen offset:3072 nt lds
    s_waitcnt lgkmcnt(0)
    v_readfirstlane_b32 s17, v17
    s_nop 0
    s_cmp_ge_i32 s17, s16
    s_cbranch_scc1 L_ldok_11
L_ldrt_12:
    ds_read_b128 v[16:19], v14 offset:16
    s_sub_u32 s18, s18, 1
    s_cbranch_scc1 L_end
    s_waitcnt lgkmcnt(0)
    v_readfirstlane_b32 s17, v17
    s_nop 0
    s_cmp_ge_i32 s17, s16
    s_cbranch_scc0 L_ldrt_12
L_ldok_11:
    ds_read_b128 v[16:19], v14 offset:16
    s_add_u32 m0, s14, 8192
    s_add_u32 s13, s12, 8192
    s_waitcnt vmcnt(21)
    buffer_load_dwordx4 v2, s[8:11], s13 offen offset:0 nt lds
    s_waitcnt vmcnt(21)
    buffer_load_dwordx4 v3, s[8:11], s13 offen offset:1024 nt lds
    s_waitcnt vmcnt(21)
    buffer_load_dwordx4 v4, s[8:11], s13 offen offset:2048 nt lds
    s_waitcnt vmcnt(21)
    buffer_load_dwordx4 v5, s[8:11], s13 offen offset:3072 nt lds
    s_add_u32 m0, s14, 12288
    s_add_u32 s13, s12, 12288
    s_waitcnt vmcnt(21)
    buffer_load_dwordx4 v6, s[8:11], s13 offen offset:0 nt lds
    s_waitcnt vmcnt(21)
    s_lshl2_add_u32 s17, s15, -1
    v_mov_b32 v15, s17
    ds_write_b32 v14, v15 offset:0
    buffer_load_dwordx4 v7, s[8:11], s13 offen offset:1024 nt lds
    s_waitcnt vmcnt(21)
    buffer_load_dwordx4 v8, s[8:11], s13 offen offset:2048 nt lds
    s_waitcnt vmcnt(21)
    buffer_load_dwordx4 v9, s[8:11], s13 offen offset:3072 nt lds
    s_waitcnt lgkmcnt(0)
    v_readfirstlane_b32 s17, v18
    s_nop 0
    s_cmp_ge_i32 s17, s16
    s_cbranch_scc1 L_ldok_13
L_ldrt_14:
    ds_read_b128 v[16:19], v14 offset:16
    s_sub_u32 s18, s18, 1
    s_cbranch_scc1 L_end
    s_waitcnt lgkmcnt(0)
    v_readfirstlane_b32 s17, v18
    s_nop 0
    s_cmp_ge_i32 s17, s16
    s_cbranch_scc0 L_ldrt_14
L_ldok_13:
    ds_read_b128 v[16:19], v14 offset:16
    s_add_u32 m0, s14, 16384
    s_add_u32 s13, s12, 16384
    s_waitcnt vmcnt(21)
    buffer_load_dwordx4 v2, s[8:11], s13 offen offset:0 nt lds
    s_waitcnt vmcnt(21)
    buffer_load_dwordx4 v3, s[8:11], s13 offen offset:1024 nt lds
    s_waitcnt vmcnt(21)
    buffer_load_dwordx4 v4, s[8:11], s13 offen offset:2048 nt lds
    s_waitcnt vmcnt(21)
    buffer_load_dwordx4 v5, s[8:11], s13 offen offset:3072 nt lds
    s_add_u32 m0, s14, 20480
    s_add_u32 s13, s12, 20480
    s_waitcnt vmcnt(21)
    buffer_load_dwordx4 v6, s[8:11], s13 offen offset:0 nt lds
    s_waitcnt vmcnt(21)
    s_lshl2_add_u32 s17, s15, 0
    v_mov_b32 v15, s17
    ds_write_b32 v14, v15 offset:0
    buffer_load_dwordx4 v7, s[8:11], s13 offen offset:1024 nt lds
    s_waitcnt vmcnt(21)
    buffer_load_dwordx4 v8, s[8:11], s13 offen offset:2048 nt lds
    s_waitcnt vmcnt(21)
    buffer_load_dwordx4 v9, s[8:11], s13 offen offset:3072 nt lds
    s_waitcnt lgkmcnt(0)
    v_readfirstlane_b32 s17, v19
    s_nop 0
    s_cmp_ge_i32 s17, s16
    s_cbranch_scc1 L_ldok_15
L_ldrt_16:
    ds_read_b128 v[16:19], v14 offset:16
    s_sub_u32 s18, s18, 1
    s_cbranch_scc1 L_end
    s_waitcnt lgkmcnt(0)
    v_readfirstlane_b32 s17, v19
    s_nop 0
    s_cmp_ge_i32 s17, s16
    s_cbranch_scc0 L_ldrt_16
L_ldok_15:
    ds_read_b128 v[16:19], v14 offset:16
    ds_read_b32 v20, v14 offset:256
    s_add_u32 m0, s14, 24576
    s_add_u32 s13, s12, 24576
    s_waitcnt vmcnt(21)
    buffer_load_dwordx4 v2, s[8:11], s13 offen offset:0 nt lds
    s_waitcnt vmcnt(21)
    buffer_load_dwordx4 v3, s[8:11], s13 offen offset:1024 nt lds
    s_waitcnt vmcnt(21)
    buffer_load_dwordx4 v4, s[8:11], s13 offen offset:2048 nt lds
    s_waitcnt vmcnt(21)
    buffer_load_dwordx4 v5, s[8:11], s13 offen offset:3072 nt lds
    s_add_u32 m0, s14, 28672
    s_add_u32 s13, s12, 28672
    s_waitcnt vmcnt(21)
    buffer_load_dwordx4 v6, s[8:11], s13 offen offset:0 nt lds
    s_waitcnt vmcnt(21)
    s_lshl2_add_u32 s17, s15, 1
    v_mov_b32 v15, s17
    ds_write_b32 v14, v15 offset:0
    buffer_load_dwordx4 v7, s[8:11], s13 offen offset:1024 nt lds
    s_waitcnt vmcnt(21)
    buffer_load_dwordx4 v8, s[8:11], s13 offen offset:2048 nt lds
    s_waitcnt vmcnt(21)
    buffer_load_dwordx4 v9, s[8:11], s13 offen offset:3072 nt lds
L_ld_e1:
    s_add_u32 s15, s15, 1
    s_cmp_lt_u32 s15, 29
    s_cbranch_scc1 L_ld_loop1
    v_add_u32 v21, 256, v14
    v_lshrrev_b32 v10, 3, v0
    v_bfe_u32 v11, v0, 4, 1
    v_lshlrev_b32 v11, 1, v11
    v_and_b32 v12, 7, v0
    v_xor_b32 v11, v11, v12
    s_lshl_b32 s17, s101, 7
    v_lshlrev_b32 v10, 9, v10
    v_add_u32 v10, s17, v10
    v_lshl_add_u32 v22, v11, 4, v10
    v_xor_b32 v23, 64, v22
    s_mov_b32 s25, 116
L_ld_pool:
    s_waitcnt lgkmcnt(0)
    v_readfirstlane_b32 s24, v20
    s_nop 0
    s_cmp_lg_u32 s24, 0
    s_cbranch_scc1 L_cqok
L_cqrt:
    ds_read_b32 v20, v21
    s_sub_u32 s18, s18, 1
    s_cbranch_scc1 L_end
    s_waitcnt lgkmcnt(0)
    v_readfirstlane_b32 s24, v20
    s_nop 0
    s_cmp_lg_u32 s24, 0
    s_cbranch_scc0 L_cqrt
L_cqok:
    s_cmp_gt_u32 s24, 24
    s_cbranch_scc1 L_ld_final
    s_sub_u32 s24, s24, 1
    s_bfe_u32 s12, s24, 0x20001
    s_lshl_b32 s12, s12, 19
    s_and_b32 s13, s24, 1
    s_lshr_b32 s24, s24, 3
    s_lshl1_add_u32 s24, s24, s13
    s_add_u32 s24, s24, 52
    s_lshl_b32 s24, s24, 13
    s_add_u32 s12, s12, s24
    s_and_b32 s14, s25, 15
    s_lshl_b32 s14, s14, 13
    s_add_u32 s16, s25, 0
    s_lshr_b32 s16, s16, 2
    s_sub_u32 s16, s16, 3
    v_min3_i32 v16, v16, v17, v18
    v_min_i32 v16, v16, v19
    s_nop 0
    v_readfirstlane_b32 s17, v16
    s_nop 0
    s_cmp_ge_i32 s17, s16
    s_cbranch_scc1 L_fok_17
L_frt_18:
    ds_read_b128 v[16:19], v14 offset:16
    s_sub_u32 s18, s18, 1
    s_cbranch_scc1 L_end
    s_waitcnt lgkmcnt(0)
    v_min3_i32 v16, v16, v17, v18
    v_min_i32 v16, v16, v19
    s_nop 0
    v_readfirstlane_b32 s17, v16
    s_nop 0
    s_cmp_ge_i32 s17, s16
    s_cbranch_scc0 L_frt_18
L_fok_17:
    v_add_u32 v21, 4, v21
    ds_read_b128 v[16:19], v14 offset:16
    ds_read_b32 v20, v21
    s_add_u32 m0, s14, 0
    s_add_u32 s13, s12, 0
    s_waitcnt vmcnt(21)
    buffer_load_dwordx4 v2, s[8:11], s13 offen offset:0 nt lds
    s_waitcnt vmcnt(21)
    buffer_load_dwordx4 v3, s[8:11], s13 offen offset:1024 nt lds
    s_waitcnt vmcnt(21)
    buffer_load_dwordx4 v4, s[8:11], s13 offen offset:2048 nt lds
    s_waitcnt vmcnt(21)
    buffer_load_dwordx4 v5, s[8:11], s13 offen offset:3072 nt lds
    s_add_u32 m0, s14, 4096
    s_add_u32 s13, s12, 4096
    s_waitcnt vmcnt(21)
    buffer_load_dwordx4 v6, s[8:11], s13 offen offset:0 nt lds
    s_waitcnt vmcnt(21)
    s_sub_u32 s17, s25, 2
    v_mov_b32 v15, s17
    ds_write_b32 v14, v15 offset:0
    buffer_load_dwordx4 v7, s[8:11], s13 offen offset:1024 nt lds
    s_waitcnt vmcnt(21)
    buffer_load_dwordx4 v8, s[8:11], s13 offen offset:2048 nt lds
    s_waitcnt vmcnt(21)
    buffer_load_dwordx4 v9, s[8:11], s13 offen offset:3072 nt lds
    s_add_u32 s25, s25, 1
    s_branch L_ld_pool
L_ld_final:
    s_add_u32 s16, s25, 5
    s_lshr_b32 s16, s16, 2
    s_sub_u32 s16, s16, 3
    v_min3_i32 v16, v16, v17, v18
    v_min_i32 v16, v16, v19
    s_nop 0
    v_readfirstlane_b32 s17, v16
    s_nop 0
    s_cmp_ge_i32 s17, s16
    s_cbranch_scc1 L_fok_19
L_frt_20:
    ds_read_b128 v[16:19], v14 offset:16
    s_sub_u32 s18, s18, 1
    s_cbranch_scc1 L_end
    s_waitcnt lgkmcnt(0)
    v_min3_i32 v16, v16, v17, v18
    v_min_i32 v16, v16, v19
    s_nop 0
    v_readfirstlane_b32 s17, v16
    s_nop 0
    s_cmp_ge_i32 s17, s16
    s_cbranch_scc0 L_frt_20
L_fok_19:
    s_add_u32 s14, s25, 0
    s_and_b32 s14, s14, 15
    s_lshl_b32 s14, s14, 13
    s_add_u32 m0, s14, 0
    s_mov_b32 s13, 475136
    buffer_load_dwordx4 v22, s[8:11], s13 offen nt lds
    s_add_u32 m0, s14, 1024
    s_mov_b32 s13, 479232
    buffer_load_dwordx4 v23, s[8:11], s13 offen nt lds
    s_add_u32 m0, s14, 2048
    s_mov_b32 s13, 483328
    buffer_load_dwordx4 v22, s[8:11], s13 offen nt lds
    s_add_u32 m0, s14, 3072
    s_mov_b32 s13, 487424
    buffer_load_dwordx4 v23, s[8:11], s13 offen nt lds
    s_add_u32 m0, s14, 4096
    s_mov_b32 s13, 491520
    buffer_load_dwordx4 v22, s[8:11], s13 offen nt lds
    s_add_u32 m0, s14, 5120
    s_mov_b32 s13, 495616
    buffer_load_dwordx4 v23, s[8:11], s13 offen nt lds
    s_add_u32 m0, s14, 6144
    s_mov_b32 s13, 499712
    s_waitcnt vmcnt(27)
    buffer_load_dwordx4 v22, s[8:11], s13 offen nt lds
    s_add_u32 m0, s14, 7168
    s_mov_b32 s13, 503808
    s_waitcnt vmcnt(27)
    buffer_load_dwordx4 v23, s[8:11], s13 offen nt lds
    s_add_u32 s14, s25, 1
    s_and_b32 s14, s14, 15
    s_lshl_b32 s14, s14, 13
    s_add_u32 m0, s14, 0
    s_mov_b32 s13, 999424
    s_waitcnt vmcnt(27)
    buffer_load_dwordx4 v22, s[8:11], s13 offen nt lds
    s_add_u32 m0, s14, 1024
    s_mov_b32 s13, 1003520
    s_waitcnt vmcnt(27)
    buffer_load_dwordx4 v23, s[8:11], s13 offen nt lds
    s_add_u32 m0, s14, 2048
    s_mov_b32 s13, 1007616
    s_waitcnt vmcnt(27)
    buffer_load_dwordx4 v22, s[8:11], s13 offen nt lds
    s_add_u32 m0, s14, 3072
    s_mov_b32 s13, 1011712
    s_waitcnt vmcnt(27)
    s_add_u32 s17, s25, -2
    v_mov_b32 v15, s17
    ds_write_b32 v14, v15 offset:0
    buffer_load_dwordx4 v23, s[8:11], s13 offen nt lds
    s_add_u32 m0, s14, 4096
    s_mov_b32 s13, 1015808
    s_waitcnt vmcnt(27)
    buffer_load_dwordx4 v22, s[8:11], s13 offen nt lds
    s_add_u32 m0, s14, 5120
    s_mov_b32 s13, 1019904
    s_waitcnt vmcnt(27)
    buffer_load_dwordx4 v23, s[8:11], s13 offen nt lds
    s_add_u32 m0, s14, 6144
    s_mov_b32 s13, 1024000
    s_waitcnt vmcnt(27)
    buffer_load_dwordx4 v22, s[8:11], s13 offen nt lds
    s_add_u32 m0, s14, 7168
    s_mov_b32 s13, 1028096
    s_waitcnt vmcnt(27)
    buffer_load_dwordx4 v23, s[8:11], s13 offen nt lds
    s_add_u32 s14, s25, 2
    s_and_b32 s14, s14, 15
    s_lshl_b32 s14, s14, 13
    s_add_u32 m0, s14, 0
    s_mov_b32 s13, 1523712
    s_waitcnt vmcnt(27)
    buffer_load_dwordx4 v22, s[8:11], s13 offen nt lds
    s_add_u32 m0, s14, 1024
    s_mov_b32 s13, 1527808
    s_waitcnt vmcnt(27)
    buffer_load_dwordx4 v23, s[8:11], s13 offen nt lds
    s_add_u32 m0, s14, 2048
    s_mov_b32 s13, 1531904
    s_waitcnt vmcnt(27)
    buffer_load_dwordx4 v22, s[8:11], s13 offen nt lds
    s_add_u32 m0, s14, 3072
    s_mov_b32 s13, 1536000
    s_waitcnt vmcnt(27)
    s_add_u32 s17, s25, -1
    v_mov_b32 v15, s17
    ds_write_b32 v14, v15 offset:0
    buffer_load_dwordx4 v23, s[8:11], s13 offen nt lds
    s_add_u32 m0, s14, 4096
    s_mov_b32 s13, 1540096
    s_waitcnt vmcnt(27)
    buffer_load_dwordx4 v22, s[8:11], s13 offen nt lds
    s_add_u32 m0, s14, 5120
    s_mov_b32 s13, 1544192
    s_waitcnt vmcnt(27)
    buffer_load_dwordx4 v23, s[8:11], s13 offen nt lds
    s_add_u32 m0, s14, 6144
    s_mov_b32 s13, 1548288
    s_waitcnt vmcnt(27)
    buffer_load_dwordx4 v22, s[8:11], s13 offen nt lds
    s_add_u32 m0, s14, 7168
    s_mov_b32 s13, 1552384
    s_waitcnt vmcnt(27)
    buffer_load_dwordx4 v23, s[8:11], s13 offen nt lds
    s_add_u32 s14, s25, 3
    s_and_b32 s14, s14, 15
    s_lshl_b32 s14, s14, 13
    s_add_u32 m0, s14, 0
    s_mov_b32 s13, 2048000
    s_waitcnt vmcnt(27)
    buffer_load_dwordx4 v22, s[8:11], s13 offen nt lds
    s_add_u32 m0, s14, 1024
    s_mov_b32 s13, 2052096
    s_waitcnt vmcnt(27)
    buffer_load_dwordx4 v23, s[8:11], s13 offen nt lds
    s_add_u32 m0, s14, 2048
    s_mov_b32 s13, 2056192
    s_waitcnt vmcnt(27)
    buffer_load_dwordx4 v22, s[8:11], s13 offen nt lds
    s_add_u32 m0, s14, 3072
    s_mov_b32 s13, 2060288
    s_waitcnt vmcnt(27)
    s_add_u32 s17, s25, 0
    v_mov_b32 v15, s17
    ds_write_b32 v14, v15 offset:0
    buffer_load_dwordx4 v23, s[8:11], s13 offen nt lds
    s_add_u32 m0, s14, 4096
    s_mov_b32 s13, 2064384
    s_waitcnt vmcnt(27)
    buffer_load_dwordx4 v22, s[8:11], s13 offen nt lds
    s_add_u32 m0, s14, 5120
    s_mov_b32 s13, 2068480
    s_waitcnt vmcnt(27)
    buffer_load_dwordx4 v23, s[8:11], s13 offen nt lds
    s_add_u32 m0, s14, 6144
    s_mov_b32 s13, 2072576
    s_waitcnt vmcnt(27)
    buffer_load_dwordx4 v22, s[8:11], s13 offen nt lds
    s_add_u32 m0, s14, 7168
    s_mov_b32 s13, 2076672
    s_waitcnt vmcnt(27)
    buffer_load_dwordx4 v23, s[8:11], s13 offen nt lds
    s_add_u32 s14, s25, 4
    s_and_b32 s14, s14, 15
    s_lshl_b32 s14, s14, 13
    s_add_u32 m0, s14, 0
    s_mov_b32 s13, 507904
    s_waitcnt vmcnt(27)
    buffer_load_dwordx4 v22, s[8:11], s13 offen nt lds
    s_add_u32 m0, s14, 1024
    s_mov_b32 s13, 512000
    s_waitcnt vmcnt(27)
    buffer_load_dwordx4 v23, s[8:11], s13 offen nt lds
    s_add_u32 m0, s14, 2048
    s_mov_b32 s13, 516096
    s_waitcnt vmcnt(27)
    buffer_load_dwordx4 v22, s[8:11], s13 offen nt lds
    s_add_u32 m0, s14, 3072
    s_mov_b32 s13, 520192
    s_waitcnt vmcnt(27)
    s_add_u32 s17, s25, 1
    v_mov_b32 v15, s17
    ds_write_b32 v14, v15 offset:0
    buffer_load_dwordx4 v23, s[8:11], s13 offen nt lds
    s_add_u32 m0, s14, 4096
    s_mov_b32 s13, 1032192
    s_waitcnt vmcnt(27)
    buffer_load_dwordx4 v22, s[8:11], s13 offen nt lds
    s_add_u32 m0, s14, 5120
    s_mov_b32 s13, 1036288
    s_waitcnt vmcnt(27)
    buffer_load_dwordx4 v23, s[8:11], s13 offen nt lds
    s_add_u32 m0, s14, 6144
    s_mov_b32 s13, 1040384
    s_waitcnt vmcnt(27)
    buffer_load_dwordx4 v22, s[8:11], s13 offen nt lds
    s_add_u32 m0, s14, 7168
    s_mov_b32 s13, 1044480
    s_waitcnt vmcnt(27)
    buffer_load_dwordx4 v23, s[8:11], s13 offen nt lds
    s_add_u32 s14, s25, 5
    s_and_b32 s14, s14, 15
    s_lshl_b32 s14, s14, 13
    s_add_u32 m0, s14, 0
    s_mov_b32 s13, 1556480
    s_waitcnt vmcnt(27)
    buffer_load_dwordx4 v22, s[8:11], s13 offen nt lds
    s_add_u32 m0, s14, 1024
    s_mov_b32 s13, 1560576
    s_waitcnt vmcnt(27)
    buffer_load_dwordx4 v23, s[8:11], s13 offen nt lds
    s_add_u32 m0, s14, 2048
    s_mov_b32 s13, 1564672
    s_waitcnt vmcnt(27)
    buffer_load_dwordx4 v22, s[8:11], s13 offen nt lds
    s_add_u32 m0, s14, 3072
    s_mov_b32 s13, 1568768
    s_waitcnt vmcnt(27)
    s_add_u32 s17, s25, 2
    v_mov_b32 v15, s17
    ds_write_b32 v14, v15 offset:0
    buffer_load_dwordx4 v23, s[8:11], s13 offen nt lds
    s_add_u32 m0, s14, 4096
    s_mov_b32 s13, 2080768
    s_waitcnt vmcnt(27)
    buffer_load_dwordx4 v22, s[8:11], s13 offen nt lds
    s_add_u32 m0, s14, 5120
    s_mov_b32 s13, 2084864
    s_waitcnt vmcnt(27)
    buffer_load_dwordx4 v23, s[8:11], s13 offen nt lds
    s_add_u32 m0, s14, 6144
    s_mov_b32 s13, 2088960
    s_waitcnt vmcnt(27)
    buffer_load_dwordx4 v22, s[8:11], s13 offen nt lds
    s_add_u32 m0, s14, 7168
    s_mov_b32 s13, 2093056
    s_waitcnt vmcnt(27)
    buffer_load_dwordx4 v23, s[8:11], s13 offen nt lds
L_ld_fin:
    s_add_u32 s17, s25, 3
    v_mov_b32 v15, s17
    s_waitcnt vmcnt(24)
    ds_write_b32 v14, v15 offset:0
    s_add_u32 s17, s25, 4
    v_mov_b32 v15, s17
    s_waitcnt vmcnt(16)
    ds_write_b32 v14, v15 offset:0
    s_add_u32 s17, s25, 5
    v_mov_b32 v15, s17
    s_waitcnt vmcnt(8)
    ds_write_b32 v14, v15 offset:0
    s_add_u32 s17, s25, 6
    v_mov_b32 v15, s17
    s_waitcnt vmcnt(0)
    ds_write_b32 v14, v15 offset:0
    s_endpgm
L_helper:
    s_load_dwordx4 s[28:31], s[0:1], 24
    s_load_dwordx2 s[46:47], s[0:1], 96
    s_load_dwordx2 s[24:25], s[0:1], 0
    s_load_dwordx8 s[36:43], s[0:1], 48
    s_load_dwordx2 s[44:45], s[0:1], 80
    s_lshl_b32 s73, s21, 3
    s_add_u32 s73, s73, s20
    s_lshl2_add_u32 s74, s73, s22
    s_lshl2_add_u32 s79, s20, s22
    s_mov_b32 s65, 0
    s_mov_b32 s66, 0x400000
    v_mov_b32 v1, 131072
    v_mov_b32 v14, 1
    v_lshrrev_b32 v10, 1, v0
    v_and_b32 v11, 1, v0
    v_lshlrev_b32 v11, 4, v11
    v_lshl_add_u32 v12, v10, 13, v11
    s_add_u32 s67, s19, 12
    s_and_b32 s67, s67, 31
    s_lshl_b32 s68, s33, 5
    s_add_u32 s68, s68, s67
    s_lshl_b32 s68, s68, 5
    s_waitcnt lgkmcnt(0)
    s_mov_b32 s67, 2162560
    s_load_dword s64, s[46:47], s67
    s_mov_b32 s56, s28
    s_mov_b32 s57, s29
    s_mov_b32 s58, 3670016
    s_mov_b32 s59, 0x20000
    v_lshrrev_b32 v4, 3, v0
    v_and_b32 v5, 7, v0
    v_lshlrev_b32 v4, 13, v4
    v_lshl_add_u32 v4, v5, 7, v4
    s_mul_i32 s67, s19, 14*8192
    s_lshl_b32 s75, s33, 10
    s_add_u32 s67, s67, s75
    s_add_u32 s75, s67, 8*8192
    v_cmp_gt_u32 vcc, 48, v0
    v_mov_b32 v5, 0x1000000
    s_nop 0
    v_cndmask_b32 v5, v5, v4, vcc
    buffer_load_dword v30, v4, s[56:59], s67 offen
    buffer_load_dword v31, v5, s[56:59], s75 offen
    s_getpc_b64 s[26:27]
L_pf:
    s_lshl_b32 s75, s19, 10
    s_min_u32 s75, s75, L_end-L_pf-1024
    s_add_u32 s26, s26, s75
    s_addc_u32 s27, s27, 0
    s_load_dword s8, s[26:27], 0
    s_load_dword s9, s[26:27], 128
    s_load_dword s10, s[26:27], 256
    s_load_dword s11, s[26:27], 384
    s_load_dword s12, s[26:27], 512
    s_load_dword s13, s[26:27], 640
    s_load_dword s14, s[26:27], 768
    s_load_dword s15, s[26:27], 896
    s_barrier
    s_waitcnt lgkmcnt(0)
    s_mov_b32 s23, 1
    s_add_u32 s67, s23, 0
    s_cmp_gt_i32 s65, s67
    s_cbranch_scc1 L_wtok_22
L_wt_21:
    ds_read_b32 v4, v1 offset:0
    s_waitcnt lgkmcnt(0)
    v_readfirstlane_b32 s65, v4
    s_nop 0
    s_cmp_gt_i32 s65, s67
    s_cbranch_scc1 L_wtok_22
    s_sub_u32 s66, s66, 1
    s_cbranch_scc1 L_end
    s_branch L_wt_21
L_wtok_22:
    s_mov_b32 m0, 147712
    s_add_u32 s67, s68, 0
    buffer_load_dwordx4 v12, s[56:59], s67 offen  lds
    s_mov_b32 m0, 148736
    s_add_u32 s67, s68, 262144
    buffer_load_dwordx4 v12, s[56:59], s67 offen  lds
    s_mov_b32 m0, 149760
    s_add_u32 s67, s68, 524288
    buffer_load_dwordx4 v12, s[56:59], s67 offen  lds
    s_mov_b32 m0, 150784
    s_add_u32 s67, s68, 786432
    s_waitcnt vmcnt(2)
    buffer_load_dwordx4 v12, s[56:59], s67 offen  lds
    s_mov_b32 m0, 151808
    s_add_u32 s67, s68, 1048576
    s_waitcnt vmcnt(2)
    buffer_load_dwordx4 v12, s[56:59], s67 offen  lds
    s_mov_b32 m0, 152832
    s_add_u32 s67, s68, 1310720
    s_waitcnt vmcnt(2)
    buffer_load_dwordx4 v12, s[56:59], s67 offen  lds
    s_mov_b32 m0, 153856
    s_add_u32 s67, s68, 1572864
    s_waitcnt vmcnt(2)
    buffer_load_dwordx4 v12, s[56:59], s67 offen  lds
    s_mov_b32 m0, 154880
    s_add_u32 s67, s68, 1835008
    s_waitcnt vmcnt(2)
    buffer_load_dwordx4 v12, s[56:59], s67 offen  lds
    s_mov_b32 m0, 155904
    s_add_u32 s67, s68, 2097152
    s_waitcnt vmcnt(2)
    buffer_load_dwordx4 v12, s[56:59], s67 offen  lds
    s_mov_b32 m0, 156928
    s_add_u32 s67, s68, 2359296
    s_waitcnt vmcnt(2)
    buffer_load_dwordx4 v12, s[56:59], s67 offen  lds
    s_mov_b32 m0, 157952
    s_add_u32 s67, s68, 2621440
    s_waitcnt vmcnt(2)
    buffer_load_dwordx4 v12, s[56:59], s67 offen  lds
    s_mov_b32 m0, 158976
    s_add_u32 s67, s68, 2883584
    s_waitcnt vmcnt(2)
    buffer_load_dwordx4 v12, s[56:59], s67 offen  lds
    s_mov_b32 m0, 160000
    s_add_u32 s67, s68, 3145728
    s_waitcnt vmcnt(2)
    buffer_load_dwordx4 v12, s[56:59], s67 offen  lds
    s_mov_b32 m0, 161024
    s_add_u32 s67, s68, 3407872
    s_waitcnt vmcnt(2)
    buffer_load_dwordx4 v12, s[56:59], s67 offen  lds
    s_mov_b32 s52, s46
    s_mov_b32 s53, s47
    s_mov_b32 s54, 2162688
    s_mov_b32 s55, 0x20000
    s_waitcnt vmcnt(0) lgkmcnt(0)
    s_add_u32 s64, s64, 1
L_wf_23:
    ds_read_b128 v[4:7], v1 offset:32
    s_waitcnt lgkmcnt(0)
    v_min3_u32 v4, v4, v5, v6
    v_min_u32 v4, v4, v7
    s_nop 0
    v_readfirstlane_b32 s67, v4
    s_nop 0
    s_cmp_lg_u32 s67, 0
    s_cbranch_scc1 L_wfok_24
    s_sub_u32 s66, s66, 1
    s_cbranch_scc1 L_end
    s_branch L_wf_23
L_wfok_24:
    v_lshrrev_b32 v4, 4, v0
    v_and_b32 v5, 15, v0
    v_lshlrev_b32 v6, 8, v4
    v_lshl_add_u32 v6, v5, 3, v6
    v_add_u32 v6, 147712, v6
    v_and_b32 v5, 7, v0
    v_mul_u32_u24 v5, 912, v5
    v_lshl_add_u32 v5, v4, 4, v5
    v_add_u32 v5, 133120, v5
    ds_read_b64_tr_b16 a[0:1], v6 offset:0
    ds_read_b64_tr_b16 a[2:3], v6 offset:128
    ds_read_b128 a[56:59], v5 offset:0
    ds_read_b64_tr_b16 a[4:5], v6 offset:1024
    ds_read_b64_tr_b16 a[6:7], v6 offset:1152
    ds_read_b128 a[60:63], v5 offset:64
    ds_read_b64_tr_b16 a[8:9], v6 offset:2048
    ds_read_b64_tr_b16 a[10:11], v6 offset:2176
    ds_read_b128 a[64:67], v5 offset:128
    ds_read_b64_tr_b16 a[12:13], v6 offset:3072
    ds_read_b64_tr_b16 a[14:15], v6 offset:3200
    ds_read_b128 a[68:71], v5 offset:192
    ds_read_b64_tr_b16 a[16:17], v6 offset:4096
    ds_read_b64_tr_b16 a[18:19], v6 offset:4224
    ds_read_b128 a[72:75], v5 offset:256
    s_waitcnt lgkmcnt(12)
    v_mfma_f32_16x16x32_bf16 v[96:99], a[0:3], a[56:59], 0
    ds_read_b64_tr_b16 a[20:21], v6 offset:5120
    ds_read_b64_tr_b16 a[22:23], v6 offset:5248
    ds_read_b128 a[76:79], v5 offset:320
    s_waitcnt lgkmcnt(12)
    v_mfma_f32_16x16x32_bf16 v[96:99], a[4:7], a[60:63], v[96:99]
    ds_read_b64_tr_b16 a[24:25], v6 offset:6144
    ds_read_b64_tr_b16 a[26:27], v6 offset:6272
    ds_read_b128 a[80:83], v5 offset:384
    s_waitcnt lgkmcnt(12)
    v_mfma_f32_16x16x32_bf16 v[96:99], a[8:11], a[64:67], v[96:99]
    ds_read_b64_tr_b16 a[28:29], v6 offset:7168
    ds_read_b64_tr_b16 a[30:31], v6 offset:7296
    ds_read_b128 a[84:87], v5 offset:448
    s_waitcnt lgkmcnt(12)
    v_mfma_f32_16x16x32_bf16 v[96:99], a[12:15], a[68:71], v[96:99]
    ds_read_b64_tr_b16 a[32:33], v6 offset:8192
    ds_read_b64_tr_b16 a[34:35], v6 offset:8320
    ds_read_b128 a[88:91], v5 offset:512
    s_waitcnt lgkmcnt(12)
    v_mfma_f32_16x16x32_bf16 v[96:99], a[16:19], a[72:75], v[96:99]
    ds_read_b64_tr_b16 a[36:37], v6 offset:9216
    ds_read_b64_tr_b16 a[38:39], v6 offset:9344
    ds_read_b128 a[92:95], v5 offset:576
    s_waitcnt lgkmcnt(12)
    v_mfma_f32_16x16x32_bf16 v[96:99], a[20:23], a[76:79], v[96:99]
    ds_read_b64_tr_b16 a[40:41], v6 offset:10240
    ds_read_b64_tr_b16 a[42:43], v6 offset:10368
    ds_read_b128 a[96:99], v5 offset:640
    s_waitcnt lgkmcnt(12)
    v_mfma_f32_16x16x32_bf16 v[96:99], a[24:27], a[80:83], v[96:99]
    ds_read_b64_tr_b16 a[44:45], v6 offset:11264
    ds_read_b64_tr_b16 a[46:47], v6 offset:11392
    ds_read_b128 a[100:103], v5 offset:704
    s_waitcnt lgkmcnt(12)
    v_mfma_f32_16x16x32_bf16 v[96:99], a[28:31], a[84:87], v[96:99]
    ds_read_b64_tr_b16 a[48:49], v6 offset:12288
    ds_read_b64_tr_b16 a[50:51], v6 offset:12416
    ds_read_b128 a[104:107], v5 offset:768
    s_waitcnt lgkmcnt(12)
    v_mfma_f32_16x16x32_bf16 v[96:99], a[32:35], a[88:91], v[96:99]
    ds_read_b64_tr_b16 a[52:53], v6 offset:13312
    ds_read_b64_tr_b16 a[54:55], v6 offset:13440
    ds_read_b128 a[108:111], v5 offset:832
    s_waitcnt lgkmcnt(12)
    v_mfma_f32_16x16x32_bf16 v[96:99], a[36:39], a[92:95], v[96:99]
    s_waitcnt lgkmcnt(9)
    v_mfma_f32_16x16x32_bf16 v[96:99], a[40:43], a[96:99], v[96:99]
    s_waitcnt lgkmcnt(6)
    v_mfma_f32_16x16x32_bf16 v[96:99], a[44:47], a[100:103], v[96:99]
    s_waitcnt lgkmcnt(3)
    v_mfma_f32_16x16x32_bf16 v[96:99], a[48:51], a[104:107], v[96:99]
    s_waitcnt lgkmcnt(0)
    v_mfma_f32_16x16x32_bf16 v[96:99], a[52:55], a[108:111], v[96:99]
    s_lshl_b32 s68, s68, 3
    v_lshrrev_b32 v8, 4, v0
    v_and_b32 v9, 15, v0
    v_lshlrev_b32 v10, 6, v9
    v_lshl_add_u32 v10, v8, 4, v10
    v_cmp_gt_u32 vcc, 8, v9
    v_mov_b32 v9, 0x1000000
    s_nop 0
    v_cndmask_b32 v10, v9, v10, vcc
    s_lshl_b32 s67, s68, 1
    s_add_u32 s67, s67, 4096
    v_mov_b32 v5, s64
    v_mov_b32 v7, s64
    v_cvt_pk_bf16_f32 v4, v96, v97
    v_cvt_pk_bf16_f32 v6, v98, v99
    buffer_store_dwordx4 v[4:7], v10, s[52:55], s67 offen sc1 nt
    s_mov_b32 s56, s36
    s_mov_b32 s57, s37
    s_mov_b32 s58, 1605632
    s_mov_b32 s59, 0x20000
    v_mul_u32_u24 v4, 52429, v0
    v_lshrrev_b32 v4, 18, v4
    v_mul_u32_u24 v5, 5, v4
    v_sub_u32 v5, v0, v5
    v_mul_u32_u24 v6, 3584, v4
    v_min_u32 v5, 3, v5
    v_cmp_eq_u32 vcc, v5, v5
    v_mul_u32_u24 v4, 52429, v0
    v_lshrrev_b32 v4, 18, v4
    v_mul_u32_u24 v5, 5, v4
    v_sub_u32 v5, v0, v5
    v_lshlrev_b32 v5, 7, v5
    v_min_u32 v5, 444, v5
    v_add_u32 v4, v6, v5
    s_mul_i32 s67, s19, 14*3584
    s_mul_i32 s75, s33, 448
    s_add_u32 s67, s67, s75
    s_add_u32 s75, s67, 12*3584
    v_cmp_gt_u32 vcc, 60, v0
    v_mov_b32 v7, 0x1000000
    s_nop 0
    v_cndmask_b32 v5, v7, v4, vcc
    v_cmp_gt_u32 vcc, 10, v0
    s_nop 1
    v_cndmask_b32 v6, v7, v4, vcc
    buffer_load_dword v30, v5, s[56:59], s67 offen
    buffer_load_dword v31, v6, s[56:59], s75 offen
    s_mov_b32 s56, s40
    s_mov_b32 s57, s41
    s_mov_b32 s58, 1605632
    s_mov_b32 s59, 0x20000
    s_mul_i32 s67, s79, 56*896
    s_mul_i32 s75, s21, 49*128
    s_add_u32 s67, s67, s75
    v_lshlrev_b32 v4, 7, v0
    v_cmp_gt_u32 vcc, 49, v0
    v_mov_b32 v7, 0x1000000
    s_nop 0
    v_cndmask_b32 v4, v7, v4, vcc
    buffer_load_dword v29, v4, s[56:59], s67 offen
    s_mov_b32 s16, s30
    s_mov_b32 s17, s31
    s_lshl_b32 s67, s74, 19
    s_add_u32 s6, s6, s67
    s_addc_u32 s7, s7, 0
    v_mov_b32 v13, 0
    s_mul_i32 s67, s79, 128*896
    s_add_u32 s30, s30, s67
    s_addc_u32 s31, s31, 0
    s_mul_i32 s67, s79, 56*896
    s_add_u32 s40, s40, s67
    s_addc_u32 s41, s41, 0
    s_load_dword s8, s[6:7], 0
    s_load_dword s9, s[30:31], 0
    s_load_dword s10, s[40:41], 0
    s_load_dword s11, s[44:45], 0
    s_load_dword s12, s[36:37], 0
    s_load_dword s13, s[38:39], 0
    s_load_dword s14, s[42:43], 0
    s_lshl_b32 s67, s21, 6
    s_lshl_b32 s75, s20, 14
    s_add_u32 s76, s67, s75
    s_add_u32 s76, s76, 4096
    v_lshrrev_b32 v12, 1, v0
    v_lshlrev_b32 v12, 9, v12
    v_and_b32 v11, 1, v0
    v_lshl_add_u32 v12, v11, 5, v12
    s_mov_b32 s23, 19
L_qpoll:
    s_add_u32 s23, s23, 2
    s_min_u32 s23, s23, 28
    s_add_u32 s67, s23, 0
    s_cmp_gt_i32 s65, s67
    s_cbranch_scc1 L_wtok_26
L_wt_25:
    ds_read_b32 v4, v1 offset:0
    s_waitcnt lgkmcnt(0)
    v_readfirstlane_b32 s65, v4
    s_nop 0
    s_cmp_gt_i32 s65, s67
    s_cbranch_scc1 L_wtok_26
    s_sub_u32 s66, s66, 1
    s_cbranch_scc1 L_end
    s_branch L_wt_25
L_wtok_26:
    buffer_load_dwordx4 v[16:19], v12, s[52:55], s76 offen sc1
    buffer_load_dwordx4 v[8:11], v12, s[52:55], s76 offen offset:16 sc1
    s_sub_u32 s66, s66, 1
    s_cbranch_scc1 L_end
    s_waitcnt vmcnt(0)
    v_xor_b32 v17, s64, v17
    v_xor_b32 v19, s64, v19
    v_xor_b32 v9, s64, v9
    v_xor_b32 v11, s64, v11
    v_or3_b32 v5, v17, v19, v9
    v_or_b32 v5, v5, v11
    v_cmp_ne_u32 vcc, 0, v5
    s_cbranch_vccnz L_qpoll
    v_mov_b32 v4, v16
    v_mov_b32 v5, v18
    v_mov_b32 v6, v8
    v_mov_b32 v7, v10
    v_lshlrev_b32 v12, 4, v0
    v_add_u32 v13, 132096, v12
    ds_write_b128 v13, v[4:7]
    ds_write_b32 v1, v14 offset:48
    s_cmp_lg_u32 s22, 0
    s_cbranch_scc1 L_noct
    v_mov_b32 v12, 0
    s_mul_i32 s67, s73, 4352
    s_add_u32 s67, s67, 1835008
    s_mov_b64 exec, 1
    buffer_store_dword v12, off, s[52:55], s67 sc1
    s_mov_b64 exec, -1
L_noct:
    s_cmp_ge_u32 s32, 14
    s_cbranch_scc1 L_noh
    s_mov_b32 s56, s36
    s_mov_b32 s57, s37
    s_mov_b32 s58, 1605632
    s_mov_b32 s59, 0x20000
    v_lshrrev_b32 v10, 1, v0
    v_and_b32 v11, 1, v0
    v_mul_u32_u24 v10, 3584, v10
    v_lshl_add_u32 v10, v11, 4, v10
    s_mul_i32 s77, s33, 14
    s_add_u32 s77, s77, s32
    s_lshl_b32 s77, s77, 5
    s_mov_b32 m0, 147712
    s_add_u32 s67, s77, 0
    buffer_load_dwordx4 v10, s[56:59], s67 offen  lds
    s_mov_b32 m0, 148736
    s_add_u32 s67, s77, 114688
    buffer_load_dwordx4 v10, s[56:59], s67 offen  lds
    s_mov_b32 m0, 149760
    s_add_u32 s67, s77, 229376
    s_waitcnt vmcnt(1)
    buffer_load_dwordx4 v10, s[56:59], s67 offen  lds
    s_mov_b32 m0, 150784
    s_add_u32 s67, s77, 344064
    s_waitcnt vmcnt(1)
    buffer_load_dwordx4 v10, s[56:59], s67 offen  lds
    s_mov_b32 m0, 151808
    s_add_u32 s67, s77, 458752
    s_waitcnt vmcnt(1)
    buffer_load_dwordx4 v10, s[56:59], s67 offen  lds
    s_mov_b32 m0, 152832
    s_add_u32 s67, s77, 573440
    s_waitcnt vmcnt(1)
    buffer_load_dwordx4 v10, s[56:59], s67 offen  lds
    s_mov_b32 m0, 153856
    s_add_u32 s67, s77, 688128
    s_waitcnt vmcnt(1)
    buffer_load_dwordx4 v10, s[56:59], s67 offen  lds
    s_mov_b32 m0, 154880
    s_add_u32 s67, s77, 802816
    s_waitcnt vmcnt(1)
    buffer_load_dwordx4 v10, s[56:59], s67 offen  lds
    s_mov_b32 m0, 155904
    s_add_u32 s67, s77, 917504
    s_waitcnt vmcnt(1)
    buffer_load_dwordx4 v10, s[56:59], s67 offen  lds
    s_mov_b32 m0, 156928
    s_add_u32 s67, s77, 1032192
    s_waitcnt vmcnt(1)
    buffer_load_dwordx4 v10, s[56:59], s67 offen  lds
    s_mov_b32 m0, 157952
    s_add_u32 s67, s77, 1146880
    s_waitcnt vmcnt(1)
    buffer_load_dwordx4 v10, s[56:59], s67 offen  lds
    s_mov_b32 m0, 158976
    s_add_u32 s67, s77, 1261568
    s_waitcnt vmcnt(1)
    buffer_load_dwordx4 v10, s[56:59], s67 offen  lds
    s_mov_b32 m0, 160000
    s_add_u32 s67, s77, 1376256
    s_waitcnt vmcnt(1)
    buffer_load_dwordx4 v10, s[56:59], s67 offen  lds
    s_mov_b32 m0, 161024
    s_add_u32 s67, s77, 1490944
    s_waitcnt vmcnt(1)
    buffer_load_dwordx4 v10, s[56:59], s67 offen  lds
    s_mov_b32 s60, s38
    s_mov_b32 s61, s39
    s_mov_b32 s62, 3584
    s_mov_b32 s63, 0x20000
    v_lshrrev_b32 v10, 4, v0
    v_lshlrev_b32 v10, 3, v10
    buffer_load_dwordx2 v[88:89], v10, s[60:63], s77 offen
L_wf_27:
    ds_read_b128 v[4:7], v1 offset:64
    s_waitcnt lgkmcnt(0)
    v_min3_u32 v4, v4, v5, v6
    v_min_u32 v4, v4, v7
    s_nop 0
    v_readfirstlane_b32 s67, v4
    s_nop 0
    s_cmp_lg_u32 s67, 0
    s_cbranch_scc1 L_wfok_28
    s_sub_u32 s66, s66, 1
    s_cbranch_scc1 L_end
    s_branch L_wf_27
L_wfok_28:
    s_waitcnt vmcnt(0)
    v_lshrrev_b32 v4, 4, v0
    v_and_b32 v5, 15, v0
    v_lshlrev_b32 v6, 8, v4
    v_lshl_add_u32 v6, v5, 3, v6
    v_add_u32 v6, 147712, v6
    v_and_b32 v5, 7, v0
    v_mul_u32_u24 v5, 912, v5
    v_lshl_add_u32 v5, v4, 4, v5
    v_add_u32 v5, 140416, v5
    ds_read_b64_tr_b16 a[0:1], v6 offset:0
    ds_read_b64_tr_b16 a[2:3], v6 offset:128
    ds_read_b128 a[56:59], v5 offset:0
    ds_read_b64_tr_b16 a[4:5], v6 offset:1024
    ds_read_b64_tr_b16 a[6:7], v6 offset:1152
    ds_read_b128 a[60:63], v5 offset:64
    ds_read_b64_tr_b16 a[8:9], v6 offset:2048
    ds_read_b64_tr_b16 a[10:11], v6 offset:2176
    ds_read_b128 a[64:67], v5 offset:128
    ds_read_b64_tr_b16 a[12:13], v6 offset:3072
    ds_read_b64_tr_b16 a[14:15], v6 offset:3200
    ds_read_b128 a[68:71], v5 offset:192
    ds_read_b64_tr_b16 a[16:17], v6 offset:4096
    ds_read_b64_tr_b16 a[18:19], v6 offset:4224
    ds_read_b128 a[72:75], v5 offset:256
    s_waitcnt lgkmcnt(12)
    v_mfma_f32_16x16x32_bf16 v[96:99], a[0:3], a[56:59], 0
    ds_read_b64_tr_b16 a[20:21], v6 offset:5120
    ds_read_b64_tr_b16 a[22:23], v6 offset:5248
    ds_read_b128 a[76:79], v5 offset:320
    s_waitcnt lgkmcnt(12)
    v_mfma_f32_16x16x32_bf16 v[96:99], a[4:7], a[60:63], v[96:99]
    ds_read_b64_tr_b16 a[24:25], v6 offset:6144
    ds_read_b64_tr_b16 a[26:27], v6 offset:6272
    ds_read_b128 a[80:83], v5 offset:384
    s_waitcnt lgkmcnt(12)
    v_mfma_f32_16x16x32_bf16 v[96:99], a[8:11], a[64:67], v[96:99]
    ds_read_b64_tr_b16 a[28:29], v6 offset:7168
    ds_read_b64_tr_b16 a[30:31], v6 offset:7296
    ds_read_b128 a[84:87], v5 offset:448
    s_waitcnt lgkmcnt(12)
    v_mfma_f32_16x16x32_bf16 v[96:99], a[12:15], a[68:71], v[96:99]
    ds_read_b64_tr_b16 a[32:33], v6 offset:8192
    ds_read_b64_tr_b16 a[34:35], v6 offset:8320
    ds_read_b128 a[88:91], v5 offset:512
    s_waitcnt lgkmcnt(12)
    v_mfma_f32_16x16x32_bf16 v[96:99], a[16:19], a[72:75], v[96:99]
    ds_read_b64_tr_b16 a[36:37], v6 offset:9216
    ds_read_b64_tr_b16 a[38:39], v6 offset:9344
    ds_read_b128 a[92:95], v5 offset:576
    s_waitcnt lgkmcnt(12)
    v_mfma_f32_16x16x32_bf16 v[96:99], a[20:23], a[76:79], v[96:99]
    ds_read_b64_tr_b16 a[40:41], v6 offset:10240
    ds_read_b64_tr_b16 a[42:43], v6 offset:10368
    ds_read_b128 a[96:99], v5 offset:640
    s_waitcnt lgkmcnt(12)
    v_mfma_f32_16x16x32_bf16 v[96:99], a[24:27], a[80:83], v[96:99]
    ds_read_b64_tr_b16 a[44:45], v6 offset:11264
    ds_read_b64_tr_b16 a[46:47], v6 offset:11392
    ds_read_b128 a[100:103], v5 offset:704
    s_waitcnt lgkmcnt(12)
    v_mfma_f32_16x16x32_bf16 v[96:99], a[28:31], a[84:87], v[96:99]
    ds_read_b64_tr_b16 a[48:49], v6 offset:12288
    ds_read_b64_tr_b16 a[50:51], v6 offset:12416
    ds_read_b128 a[104:107], v5 offset:768
    s_waitcnt lgkmcnt(12)
    v_mfma_f32_16x16x32_bf16 v[96:99], a[32:35], a[88:91], v[96:99]
    ds_read_b64_tr_b16 a[52:53], v6 offset:13312
    ds_read_b64_tr_b16 a[54:55], v6 offset:13440
    ds_read_b128 a[108:111], v5 offset:832
    s_waitcnt lgkmcnt(12)
    v_mfma_f32_16x16x32_bf16 v[96:99], a[36:39], a[92:95], v[96:99]
    s_waitcnt lgkmcnt(9)
    v_mfma_f32_16x16x32_bf16 v[96:99], a[40:43], a[96:99], v[96:99]
    s_waitcnt lgkmcnt(6)
    v_mfma_f32_16x16x32_bf16 v[96:99], a[44:47], a[100:103], v[96:99]
    s_waitcnt lgkmcnt(3)
    v_mfma_f32_16x16x32_bf16 v[96:99], a[48:51], a[104:107], v[96:99]
    s_waitcnt lgkmcnt(0)
    v_mfma_f32_16x16x32_bf16 v[96:99], a[52:55], a[108:111], v[96:99]
    v_lshlrev_b32 v8, 16, v88
    v_and_b32 v9, 0xffff0000, v88
    v_lshlrev_b32 v10, 16, v89
    v_and_b32 v11, 0xffff0000, v89
    s_mov_b32 s75, 0xbdd2d3e8
    v_mov_b32 v12, 0xc0135761
    s_nop 1
    v_cvt_pk_bf16_f32 v96, v96, v96
    v_lshlrev_b32 v96, 16, v96
    v_cvt_pk_bf16_f32 v97, v97, v97
    v_lshlrev_b32 v97, 16, v97
    v_cvt_pk_bf16_f32 v98, v98, v98
    v_lshlrev_b32 v98, 16, v98
    v_cvt_pk_bf16_f32 v99, v99, v99
    v_lshlrev_b32 v99, 16, v99
    v_add_f32 v96, v96, v8
    v_add_f32 v97, v97, v9
    v_add_f32 v98, v98, v10
    v_add_f32 v99, v99, v11
    v_cvt_pk_bf16_f32 v96, v96, v96
    v_lshlrev_b32 v96, 16, v96
    v_cvt_pk_bf16_f32 v97, v97, v97
    v_lshlrev_b32 v97, 16, v97
    v_cvt_pk_bf16_f32 v98, v98, v98
    v_lshlrev_b32 v98, 16, v98
    v_cvt_pk_bf16_f32 v99, v99, v99
    v_lshlrev_b32 v99, 16, v99
    v_mul_f32 v8, v96, v96
    v_fma_f32 v8, v8, s75, v12
    v_mul_f32 v8, v8, v96
    v_mul_f32 v9, v97, v97
    v_fma_f32 v9, v9, s75, v12
    v_mul_f32 v9, v9, v97
    v_mul_f32 v10, v98, v98
    v_fma_f32 v10, v10, s75, v12
    v_mul_f32 v10, v10, v98
    v_mul_f32 v11, v99, v99
    v_fma_f32 v11, v11, s75, v12
    v_mul_f32 v11, v11, v99
    v_exp_f32 v8, v8
    v_exp_f32 v9, v9
    v_exp_f32 v10, v10
    v_exp_f32 v11, v11
    v_add_f32 v8, 1.0, v8
    v_add_f32 v9, 1.0, v9
    v_add_f32 v10, 1.0, v10
    v_add_f32 v11, 1.0, v11
    v_rcp_f32 v8, v8
    v_rcp_f32 v9, v9
    v_rcp_f32 v10, v10
    v_rcp_f32 v11, v11
    v_mul_f32 v96, v96, v8
    v_mul_f32 v97, v97, v9
    v_mul_f32 v98, v98, v10
    v_mul_f32 v99, v99, v11
    v_lshrrev_b32 v8, 4, v0
    v_and_b32 v9, 15, v0
    v_lshlrev_b32 v10, 13, v9
    v_lshl_add_u32 v10, v8, 4, v10
    v_cmp_gt_u32 vcc, 8, v9
    v_mov_b32 v9, 0x1000000
    s_nop 0
    v_cndmask_b32 v10, v9, v10, vcc
    s_lshl_b32 s67, s77, 1
    s_add_u32 s67, s67, 135168
    v_mov_b32 v5, s64
    v_mov_b32 v7, s64
    v_cvt_pk_bf16_f32 v4, v96, v97
    v_cvt_pk_bf16_f32 v6, v98, v99
    buffer_store_dwordx4 v[4:7], v10, s[52:55], s67 offen sc1 nt
L_noh:
    s_mov_b32 s48, s24
    s_mov_b32 s49, s25
    s_mov_b32 s50, 7168
    s_mov_b32 s51, 0x20000
    s_mov_b32 s56, s42
    s_mov_b32 s57, s43
    s_mov_b32 s58, 896
    s_mov_b32 s59, 0x20000
    v_and_b32 v11, 3, v0
    v_bfe_u32 v10, v0, 2, 2
    v_lshl_add_u32 v10, v11, 2, v10
    v_lshlrev_b32 v10, 1, v10
    s_lshl_b32 s75, s79, 5
    s_mul_i32 s78, s21, 896
    s_add_u32 s78, s78, s75
    buffer_load_ushort v8, v10, s[48:51], s78 offen
    buffer_load_ushort v9, v10, s[56:59], s75 offen
    v_mov_b32 v13, 0x1000000
    v_cmp_gt_u32 vcc, 16, v0
    s_nop 1
    v_cndmask_b32 v33, v13, v10, vcc
    v_lshrrev_b32 v10, 2, v0
    v_lshlrev_b32 v10, 11, v10
    v_lshl_add_u32 v32, v11, 4, v10
    s_lshl_b32 s77, s21, 16
    s_lshl_b32 s67, s79, 6
    s_add_u32 s77, s77, s67
    s_add_u32 s77, s77, 786432
    s_waitcnt vmcnt(0)
    v_lshlrev_b32 v8, 16, v8
    v_lshlrev_b32 v9, 16, v9
    v_add_f32 v3, v8, v9
    s_mov_b32 s23, 40
    s_add_u32 s67, s23, 0
    s_cmp_gt_i32 s65, s67
    s_cbranch_scc1 L_wtok_30
L_wt_29:
    ds_read_b32 v4, v1 offset:0
    s_waitcnt lgkmcnt(0)
    v_readfirstlane_b32 s65, v4
    s_nop 0
    s_cmp_gt_i32 s65, s67
    s_cbranch_scc1 L_wtok_30
    s_sub_u32 s66, s66, 1
    s_cbranch_scc1 L_end
    s_branch L_wt_29
L_wtok_30:
    s_mov_b32 s56, s16
    s_mov_b32 s57, s17
    s_mov_b32 s58, 3670016
    s_mov_b32 s59, 0x20000
    s_lshl_b32 s67, s20, 3
    s_add_u32 s67, s67, s101
    s_mul_i32 s67, s67, 64*896
    s_mul_i32 s75, s21, 56*128
    s_add_u32 s67, s67, s75
    s_add_u32 s75, s67, 256*896
    v_lshlrev_b32 v4, 7, v0
    v_cmp_gt_u32 vcc, 56, v0
    s_nop 1
    v_cndmask_b32 v4, v13, v4, vcc
    buffer_load_dword v30, v4, s[56:59], s67 offen
    buffer_load_dword v31, v4, s[56:59], s75 offen
L_wf_31:
    ds_read_b128 v[4:7], v1 offset:80
    s_waitcnt lgkmcnt(0)
    v_min3_u32 v4, v4, v5, v6
    v_min_u32 v4, v4, v7
    s_nop 0
    v_readfirstlane_b32 s67, v4
    s_nop 0
    s_cmp_lg_u32 s67, 0
    s_cbranch_scc1 L_wfok_32
    s_sub_u32 s66, s66, 1
    s_cbranch_scc1 L_end
    s_branch L_wf_31
L_wfok_32:
    v_lshlrev_b32 v12, 4, v0
    v_add_u32 v11, 133120, v12
    v_cmp_gt_u32 vcc, 48, v0
    s_nop 1
    v_cndmask_b32 v28, v13, v12, vcc
    ds_read_b128 v[20:23], v11 offset:0
    s_lshl_b32 s75, s74, 11
    s_add_u32 s75, s75, 1310720
    s_waitcnt lgkmcnt(0)
    buffer_store_dwordx4 v[20:23], v28, s[52:55], s75 offen offset:0 sc1 nt
L_wf_33:
    ds_read_b128 v[4:7], v1 offset:96
    s_waitcnt lgkmcnt(0)
    v_min3_u32 v4, v4, v5, v6
    v_min_u32 v4, v4, v7
    s_nop 0
    v_readfirstlane_b32 s67, v4
    s_nop 0
    s_cmp_lg_u32 s67, 0
    s_cbranch_scc1 L_wfok_34
    s_sub_u32 s66, s66, 1
    s_cbranch_scc1 L_end
    s_branch L_wf_33
L_wfok_34:
    v_bfe_u32 v10, v0, 3, 1
    v_lshl_add_u32 v10, v10, 2, v1
    ds_read2_b32 v[4:5], v10 offset0:40 offset1:42
    ds_read2_b32 v[6:7], v10 offset0:44 offset1:46
    ds_read2_b32 v[16:17], v10 offset0:32 offset1:34
    ds_read2_b32 v[18:19], v10 offset0:36 offset1:38
    v_and_b32 v8, 0x37, v0
    v_cmp_eq_u32 vcc, 0, v8
    v_lshlrev_b32 v8, 1, v0
    s_nop 0
    v_cndmask_b32 v8, v13, v8, vcc
    s_lshl_b32 s67, s74, 7
    s_add_u32 s67, s67, 200704
    s_waitcnt lgkmcnt(0)
    v_add_f32 v4, v4, v5
    v_add_f32 v6, v6, v7
    v_add_f32 v6, v4, v6
    v_max3_f32 v4, v16, v17, v18
    v_max_f32 v4, v4, v19
    v_mov_b32 v5, s64
    v_mov_b32 v7, s64
    s_waitcnt vmcnt(0)
    buffer_store_dwordx4 v[4:7], v8, s[52:55], s67 offen sc1
    s_lshl_b32 s67, s73, 9
    s_add_u32 s67, s67, 200704
    s_add_u32 s26, s46, s67
    s_addc_u32 s27, s47, 0
    s_mov_b32 s23, 80
    s_add_u32 s67, s23, 0
    s_cmp_gt_i32 s65, s67
    s_cbranch_scc1 L_wtok_36
L_wt_35:
    ds_read_b32 v4, v1 offset:0
    s_waitcnt lgkmcnt(0)
    v_readfirstlane_b32 s65, v4
    s_nop 0
    s_cmp_gt_i32 s65, s67
    s_cbranch_scc1 L_wtok_36
    s_sub_u32 s66, s66, 1
    s_cbranch_scc1 L_end
    s_branch L_wt_35
L_wtok_36:
L_stp:
    s_load_dwordx8 s[4:11], s[26:27], 0 glc
    s_load_dwordx8 s[12:19], s[26:27], 128 glc
    s_load_dwordx8 s[36:43], s[26:27], 256 glc
    s_load_dwordx8 s[56:63], s[26:27], 384 glc
    s_sub_u32 s66, s66, 1
    s_cbranch_scc1 L_end
    s_waitcnt lgkmcnt(0)
    s_xor_b32 s67, s5, s64
    s_xor_b32 s75, s7, s64
    s_or_b32 s67, s67, s75
    s_xor_b32 s75, s9, s64
    s_or_b32 s67, s67, s75
    s_xor_b32 s75, s11, s64
    s_or_b32 s67, s67, s75
    s_xor_b32 s75, s13, s64
    s_or_b32 s67, s67, s75
    s_xor_b32 s75, s15, s64
    s_or_b32 s67, s67, s75
    s_xor_b32 s75, s17, s64
    s_or_b32 s67, s67, s75
    s_xor_b32 s75, s19, s64
    s_or_b32 s67, s67, s75
    s_xor_b32 s75, s37, s64
    s_or_b32 s67, s67, s75
    s_xor_b32 s75, s39, s64
    s_or_b32 s67, s67, s75
    s_xor_b32 s75, s41, s64
    s_or_b32 s67, s67, s75
    s_xor_b32 s75, s43, s64
    s_or_b32 s67, s67, s75
    s_xor_b32 s75, s57, s64
    s_or_b32 s67, s67, s75
    s_xor_b32 s75, s59, s64
    s_or_b32 s67, s67, s75
    s_xor_b32 s75, s61, s64
    s_or_b32 s67, s67, s75
    s_xor_b32 s75, s63, s64
    s_or_b32 s67, s67, s75
    s_cmp_eq_u32 s67, 0
    s_cbranch_scc1 L_stp_ok
    s_add_u32 s23, s65, 1
    s_min_u32 s23, s23, 110
    s_add_u32 s67, s23, 0
    s_cmp_gt_i32 s65, s67
    s_cbranch_scc1 L_wtok_38
L_wt_37:
    ds_read_b32 v4, v1 offset:0
    s_waitcnt lgkmcnt(0)
    v_readfirstlane_b32 s65, v4
    s_nop 0
    s_cmp_gt_i32 s65, s67
    s_cbranch_scc1 L_wtok_38
    s_sub_u32 s66, s66, 1
    s_cbranch_scc1 L_end
    s_branch L_wt_37
L_wtok_38:
    s_branch L_stp
L_stp_ok:
    s_lshl_b32 s67, s73, 13
    s_add_u32 s67, s67, 1310720
    s_add_u32 s72, s67, 4096
    buffer_load_dwordx4 v[48:51], v28, s[52:55], s67 offen offset:0 sc1
    buffer_load_dwordx4 v[56:59], v28, s[52:55], s67 offen offset:2048 sc1
    buffer_load_dwordx4 v[64:67], v28, s[52:55], s72 offen offset:0 sc1
    buffer_load_dwordx4 v[72:75], v28, s[52:55], s72 offen offset:2048 sc1
    s_mov_b32 s75, 0x3db8aa3b
    v_mov_b32 v4, s4
    v_mov_b32 v8, s6
    v_mov_b32 v5, s12
    v_mov_b32 v9, s14
    v_mov_b32 v6, s36
    v_mov_b32 v10, s38
    v_mov_b32 v7, s56
    v_mov_b32 v11, s58
    v_max3_f32 v16, v4, v5, v6
    v_max_f32 v16, v16, v7
    v_mul_f32 v22, 0xbdb8aa3b, v16
    v_fma_f32 v4, v4, s75, v22
    v_fma_f32 v5, v5, s75, v22
    v_fma_f32 v6, v6, s75, v22
    v_fma_f32 v7, v7, s75, v22
    v_exp_f32 v4, v4
    v_exp_f32 v5, v5
    v_exp_f32 v6, v6
    v_exp_f32 v7, v7
    v_mul_f32 v8, v8, v4
    v_fmac_f32 v8, v9, v5
    v_fmac_f32 v8, v10, v6
    v_fmac_f32 v8, v11, v7
    v_rcp_f32 v18, v8
    v_mov_b32 v20, v4
    s_cmp_eq_u32 s22, 1
    s_cselect_b64 vcc, -1, 0
    v_cndmask_b32 v20, v20, v5, vcc
    s_cmp_eq_u32 s22, 2
    s_cselect_b64 vcc, -1, 0
    v_cndmask_b32 v20, v20, v6, vcc
    s_cmp_eq_u32 s22, 3
    s_cselect_b64 vcc, -1, 0
    v_cndmask_b32 v20, v20, v7, vcc
    v_mov_b32 v4, s8
    v_mov_b32 v8, s10
    v_mov_b32 v5, s16
    v_mov_b32 v9, s18
    v_mov_b32 v6, s40
    v_mov_b32 v10, s42
    v_mov_b32 v7, s60
    v_mov_b32 v11, s62
    v_max3_f32 v17, v4, v5, v6
    v_max_f32 v17, v17, v7
    v_mul_f32 v23, 0xbdb8aa3b, v17
    v_fma_f32 v4, v4, s75, v23
    v_fma_f32 v5, v5, s75, v23
    v_fma_f32 v6, v6, s75, v23
    v_fma_f32 v7, v7, s75, v23
    v_exp_f32 v4, v4
    v_exp_f32 v5, v5
    v_exp_f32 v6, v6
    v_exp_f32 v7, v7
    v_mul_f32 v8, v8, v4
    v_fmac_f32 v8, v9, v5
    v_fmac_f32 v8, v10, v6
    v_fmac_f32 v8, v11, v7
    v_rcp_f32 v19, v8
    v_mov_b32 v21, v4
    s_cmp_eq_u32 s22, 1
    s_cselect_b64 vcc, -1, 0
    v_cndmask_b32 v21, v21, v5, vcc
    s_cmp_eq_u32 s22, 2
    s_cselect_b64 vcc, -1, 0
    v_cndmask_b32 v21, v21, v6, vcc
    s_cmp_eq_u32 s22, 3
    s_cselect_b64 vcc, -1, 0
    v_cndmask_b32 v21, v21, v7, vcc
    ds_write_b32 v1, v20 offset:196
    ds_write_b32 v1, v21 offset:200
    ds_write_b32 v1, v18 offset:204
    ds_write_b32 v1, v19 offset:208
    v_add_u32 v11, 153856, v12
    s_waitcnt vmcnt(3)
    v_lshlrev_b32 v4, 16, v48
    v_and_b32 v5, 0xffff0000, v48
    v_fma_f32 v4, v4, s75, v22
    v_fma_f32 v5, v5, s75, v22
    v_exp_f32 v4, v4
    v_exp_f32 v5, v5
    s_nop 0
    v_cvt_pk_bf16_f32 v48, v4, v5
    v_lshlrev_b32 v6, 16, v49
    v_and_b32 v7, 0xffff0000, v49
    v_fma_f32 v6, v6, s75, v22
    v_fma_f32 v7, v7, s75, v22
    v_exp_f32 v6, v6
    v_exp_f32 v7, v7
    s_nop 0
    v_cvt_pk_bf16_f32 v49, v6, v7
    v_lshlrev_b32 v4, 16, v50
    v_and_b32 v5, 0xffff0000, v50
    v_fma_f32 v4, v4, s75, v23
    v_fma_f32 v5, v5, s75, v23
    v_exp_f32 v4, v4
    v_exp_f32 v5, v5
    s_nop 0
    v_cvt_pk_bf16_f32 v50, v4, v5
    v_lshlrev_b32 v6, 16, v51
    v_and_b32 v7, 0xffff0000, v51
    v_fma_f32 v6, v6, s75, v23
    v_fma_f32 v7, v7, s75, v23
    v_exp_f32 v6, v6
    v_exp_f32 v7, v7
    s_nop 0
    v_cvt_pk_bf16_f32 v51, v6, v7
    ds_write_b128 v11, v[48:51] offset:0
    s_waitcnt vmcnt(2)
    v_lshlrev_b32 v4, 16, v56
    v_and_b32 v5, 0xffff0000, v56
    v_fma_f32 v4, v4, s75, v22
    v_fma_f32 v5, v5, s75, v22
    v_exp_f32 v4, v4
    v_exp_f32 v5, v5
    s_nop 0
    v_cvt_pk_bf16_f32 v56, v4, v5
    v_lshlrev_b32 v6, 16, v57
    v_and_b32 v7, 0xffff0000, v57
    v_fma_f32 v6, v6, s75, v22
    v_fma_f32 v7, v7, s75, v22
    v_exp_f32 v6, v6
    v_exp_f32 v7, v7
    s_nop 0
    v_cvt_pk_bf16_f32 v57, v6, v7
    v_lshlrev_b32 v4, 16, v58
    v_and_b32 v5, 0xffff0000, v58
    v_fma_f32 v4, v4, s75, v23
    v_fma_f32 v5, v5, s75, v23
    v_exp_f32 v4, v4
    v_exp_f32 v5, v5
    s_nop 0
    v_cvt_pk_bf16_f32 v58, v4, v5
    v_lshlrev_b32 v6, 16, v59
    v_and_b32 v7, 0xffff0000, v59
    v_fma_f32 v6, v6, s75, v23
    v_fma_f32 v7, v7, s75, v23
    v_exp_f32 v6, v6
    v_exp_f32 v7, v7
    s_nop 0
    v_cvt_pk_bf16_f32 v59, v6, v7
    ds_write_b128 v11, v[56:59] offset:2048
    s_waitcnt vmcnt(1)
    v_lshlrev_b32 v4, 16, v64
    v_and_b32 v5, 0xffff0000, v64
    v_fma_f32 v4, v4, s75, v22
    v_fma_f32 v5, v5, s75, v22
    v_exp_f32 v4, v4
    v_exp_f32 v5, v5
    s_nop 0
    v_cvt_pk_bf16_f32 v64, v4, v5
    v_lshlrev_b32 v6, 16, v65
    v_and_b32 v7, 0xffff0000, v65
    v_fma_f32 v6, v6, s75, v22
    v_fma_f32 v7, v7, s75, v22
    v_exp_f32 v6, v6
    v_exp_f32 v7, v7
    s_nop 0
    v_cvt_pk_bf16_f32 v65, v6, v7
    v_lshlrev_b32 v4, 16, v66
    v_and_b32 v5, 0xffff0000, v66
    v_fma_f32 v4, v4, s75, v23
    v_fma_f32 v5, v5, s75, v23
    v_exp_f32 v4, v4
    v_exp_f32 v5, v5
    s_nop 0
    v_cvt_pk_bf16_f32 v66, v4, v5
    v_lshlrev_b32 v6, 16, v67
    v_and_b32 v7, 0xffff0000, v67
    v_fma_f32 v6, v6, s75, v23
    v_fma_f32 v7, v7, s75, v23
    v_exp_f32 v6, v6
    v_exp_f32 v7, v7
    s_nop 0
    v_cvt_pk_bf16_f32 v67, v6, v7
    ds_write_b128 v11, v[64:67] offset:4096
    s_waitcnt vmcnt(0)
    v_lshlrev_b32 v4, 16, v72
    v_and_b32 v5, 0xffff0000, v72
    v_fma_f32 v4, v4, s75, v22
    v_fma_f32 v5, v5, s75, v22
    v_exp_f32 v4, v4
    v_exp_f32 v5, v5
    s_nop 0
    v_cvt_pk_bf16_f32 v72, v4, v5
    v_lshlrev_b32 v6, 16, v73
    v_and_b32 v7, 0xffff0000, v73
    v_fma_f32 v6, v6, s75, v22
    v_fma_f32 v7, v7, s75, v22
    v_exp_f32 v6, v6
    v_exp_f32 v7, v7
    s_nop 0
    v_cvt_pk_bf16_f32 v73, v6, v7
    v_lshlrev_b32 v4, 16, v74
    v_and_b32 v5, 0xffff0000, v74
    v_fma_f32 v4, v4, s75, v23
    v_fma_f32 v5, v5, s75, v23
    v_exp_f32 v4, v4
    v_exp_f32 v5, v5
    s_nop 0
    v_cvt_pk_bf16_f32 v74, v4, v5
    v_lshlrev_b32 v6, 16, v75
    v_and_b32 v7, 0xffff0000, v75
    v_fma_f32 v6, v6, s75, v23
    v_fma_f32 v7, v7, s75, v23
    v_exp_f32 v6, v6
    v_exp_f32 v7, v7
    s_nop 0
    v_cvt_pk_bf16_f32 v75, v6, v7
    ds_write_b128 v11, v[72:75] offset:6144
    ds_write_b32 v1, v14 offset:192
    s_mov_b32 s56, s44
    s_mov_b32 s57, s45
    s_mov_b32 s58, 7168
    s_mov_b32 s59, 0x20000
    s_add_u32 s72, s77, 32768
    s_mul_i32 s67, s73, 4352
    s_add_u32 s67, s67, 1835008
    s_add_u32 s26, s46, s67
    s_addc_u32 s27, s47, 0
    s_mov_b32 s23, 109
    v_add_u32 v11, 256, v1
    s_mov_b32 s24, 0
    s_cmp_eq_u32 s101, 3
    s_cselect_b32 s35, 16, 24
L_claim:
    s_cmp_lt_i32 s24, 20
    s_cselect_b32 s25, 2, 1
    s_add_u32 s67, s23, 0
    s_cmp_gt_i32 s65, s67
    s_cbranch_scc1 L_wtok_40
L_wt_39:
    ds_read_b32 v4, v1 offset:0
    s_waitcnt lgkmcnt(0)
    v_readfirstlane_b32 s65, v4
    s_nop 0
    s_cmp_gt_i32 s65, s67
    s_cbranch_scc1 L_wtok_40
    s_sub_u32 s66, s66, 1
    s_cbranch_scc1 L_end
    s_branch L_wt_39
L_wtok_40:
    s_mov_b32 s24, s25
    s_atomic_add s24, s[26:27], 0 glc
    s_waitcnt lgkmcnt(0)
L_claim_put:
    s_add_u32 s24, s24, 1
    s_cmp_gt_u32 s24, 24
    s_cbranch_scc1 L_claim_end
    v_mov_b32 v4, s24
    ds_write_b32 v11, v4
    v_add_u32 v11, 4, v11
    s_add_u32 s23, s23, 1
    s_sub_u32 s25, s25, 1
    s_cmp_lg_u32 s25, 0
    s_cbranch_scc1 L_claim_put
    s_cmp_lt_u32 s24, s35
    s_cbranch_scc1 L_claim
L_claim_end:
    s_add_u32 s24, s23, 7
    v_mov_b32 v4, s24
    ds_write_b32 v11, v4 offset:0
    ds_write_b32 v11, v4 offset:4
    ds_write_b32 v11, v4 offset:8
    ds_write_b32 v11, v4 offset:12
    v_lshlrev_b32 v10, 7, v0
    v_cmp_gt_u32 vcc, 14, v0
    v_mov_b32 v5, 0x1000000
    s_nop 0
    v_cndmask_b32 v10, v5, v10, vcc
    s_lshl_b32 s75, s74, 11
    s_add_u32 s75, s75, 786432
    buffer_load_dword v29, v10, s[52:55], s75 offen sc1
    s_waitcnt vmcnt(0)
    s_cmp_ge_u32 s79, 28
    s_cbranch_scc1 L_end
    s_mul_i32 s34, s64, 0x3d2f1b65
    s_mov_b32 s8, 0x07060500
    s_mov_b32 s9, 0x07060501
    s_mov_b32 s10, 0x07060502
    s_mov_b32 s11, 0x07060503
    s_mov_b32 s12, 0x0c0c0400
    s_mov_b32 s13, 0x04000c0c
    s_cmp_eq_u32 s74, 0
    s_cselect_b32 s67, 1, 0
    v_cmp_gt_u32 vcc, s67, v0
    v_mov_b32 v34, s64
    v_mov_b32 v4, 2162560
    v_mov_b32 v5, 0x1000000
    v_cndmask_b32 v35, v5, v4, vcc
    s_barrier
L_hop2:
    buffer_load_dwordx4 v[48:51], v32, s[52:55], s77 offen sc1
    buffer_load_dwordx4 v[52:55], v32, s[52:55], s72 offen sc1
    s_sub_u32 s66, s66, 1
    s_cbranch_scc1 L_end
    s_waitcnt vmcnt(1)
    v_perm_b32 v12, v49, v48, s12
    v_perm_b32 v13, v51, v50, s13
    v_or_b32 v12, v12, v13
    s_waitcnt vmcnt(0)
    v_perm_b32 v4, v53, v52, s12
    v_perm_b32 v5, v55, v54, s13
    v_or_b32 v4, v4, v5
    v_xor_b32 v12, s34, v12
    v_xor_b32 v4, s34, v4
    v_or_b32 v12, v12, v4
    v_cmp_ne_u32 vcc, 0, v12
    s_cbranch_vccnz L_hop2
    v_pk_add_f32 v[8:9], v[48:49], v[52:53]
    v_pk_add_f32 v[10:11], v[50:51], v[54:55]
    buffer_store_dword v34, v35, s[52:55], 0 offen
    v_add_f32_dpp v4, v8, v8 row_ror:8 row_mask:0xf bank_mask:0x3
    v_add_f32_dpp v5, v9, v9 row_ror:8 row_mask:0xf bank_mask:0x3
    v_add_f32_dpp v4, v10, v10 row_ror:8 row_mask:0xf bank_mask:0xc
    v_add_f32_dpp v5, v11, v11 row_ror:8 row_mask:0xf bank_mask:0xc
    s_nop 0
    v_add_f32_dpp v6, v4, v4 row_shl:4 row_mask:0xf bank_mask:0x5
    v_add_f32_dpp v6, v5, v5 row_shr:4 row_mask:0xf bank_mask:0xa
    v_mov_b32 v7, v6
    s_nop 1
    v_permlane16_swap_b32 v6, v7
    v_add_f32 v6, v6, v7
    v_mov_b32 v7, v6
    s_nop 1
    v_permlane32_swap_b32 v6, v7
    v_add_f32 v6, v6, v7
    v_add_f32 v6, v6, v3
    v_cvt_pk_bf16_f32 v6, v6, v6
    buffer_store_short v6, v33, s[56:59], s78 offen
    s_branch L_end
L_consumer:
    s_load_dwordx2 s[24:25], s[0:1], 0
    s_load_dwordx2 s[46:47], s[0:1], 96
    s_load_dwordx2 s[30:31], s[0:1], 32
    s_load_dwordx2 s[40:41], s[0:1], 64
    s_sub_u32 s23, s3, 1
    v_lshrrev_b32 v6, 5, v0
    v_and_b32 v7, 31, v0
    s_lshl_b32 s67, s23, 1
    v_add_u32 v6, s67, v6
    v_mul_u32_u24 v8, 896, v6
    v_lshl_add_u32 v8, v7, 4, v8
    v_cmp_gt_u32 vcc, 28, v7
    v_mov_b32 v9, 0x10000
    s_nop 0
    v_cndmask_b32 v8, v9, v8, vcc
    s_mov_b32 s50, 7168
    s_mov_b32 s51, 0x20000
    s_waitcnt lgkmcnt(0)
    s_mov_b32 s48, s24
    s_mov_b32 s49, s25
    buffer_load_dwordx4 v[16:19], v8, s[48:51], 0 offen
    buffer_load_dwordx4 v[20:23], v8, s[48:51], 0 offen offset:448
    s_mov_b32 s67, 2162560
    s_load_dword s64, s[46:47], s67
    v_cndmask_b32 v40, 0, 1.0, vcc
    v_mul_u32_u24 v41, 912, v6
    v_lshl_add_u32 v41, v7, 4, v41
    v_add_u32 v41, 133120, v41
    s_mov_b64 s[70:71], vcc
    s_lshl_b32 s73, s21, 3
    s_add_u32 s73, s73, s20
    s_lshl2_add_u32 s74, s73, s22
    s_lshl2_add_u32 s79, s20, s22
    s_mov_b32 s65, 0
    s_mov_b32 s66, 0x400000
    v_mov_b32 v1, 131072
    v_mov_b32 v14, 1
    s_lshl_b32 s67, s23, 2
    v_add_u32 v15, s67, v1
    s_mov_b32 s52, s46
    s_mov_b32 s53, s47
    s_mov_b32 s54, 2162688
    s_mov_b32 s55, 0x20000
    v_and_b32 v10, 1, v0
    v_bfe_u32 v11, v0, 1, 2
    v_cmp_eq_u32 vcc, 0, v10
    v_mov_b32 v12, 0x01000c0c
    v_mov_b32 v13, 0x0c0c0100
    v_cndmask_b32 v12, v12, v13, vcc
    v_mov_b32 v10, 0x03020c0c
    v_mov_b32 v13, 0x0c0c0302
    v_cndmask_b32 v13, v10, v13, vcc
    v_mov_b32 v10, 0x0c0c0c0c
    v_cmp_eq_u32 vcc, 0, v11
    s_nop 1
    v_cndmask_b32 v80, v10, v12, vcc
    v_cndmask_b32 v84, v10, v13, vcc
    v_cmp_eq_u32 vcc, 1, v11
    s_nop 1
    v_cndmask_b32 v81, v10, v12, vcc
    v_cndmask_b32 v85, v10, v13, vcc
    v_cmp_eq_u32 vcc, 2, v11
    s_nop 1
    v_cndmask_b32 v82, v10, v12, vcc
    v_cndmask_b32 v86, v10, v13, vcc
    v_cmp_eq_u32 vcc, 3, v11
    s_nop 1
    v_cndmask_b32 v83, v10, v12, vcc
    v_cndmask_b32 v87, v10, v13, vcc
    v_lshrrev_b32 v10, 4, v0
    v_and_b32 v11, 15, v0
    s_lshl_b32 s67, s23, 13
    v_lshlrev_b32 v12, 9, v11
    v_add_u32 v12, s67, v12
    v_add_u32 v13, 0, v10
    v_xor_b32 v13, v13, v11
    v_lshl_add_u32 v100, v13, 4, v12
    v_add_u32 v104, 0x10000, v100
    v_add_u32 v13, 4, v10
    v_xor_b32 v13, v13, v11
    v_lshl_add_u32 v101, v13, 4, v12
    v_add_u32 v105, 0x10000, v101
    v_add_u32 v13, 8, v10
    v_xor_b32 v13, v13, v11
    v_lshl_add_u32 v102, v13, 4, v12
    v_add_u32 v106, 0x10000, v102
    v_add_u32 v13, 12, v10
    v_xor_b32 v13, v13, v11
    v_lshl_add_u32 v103, v13, 4, v12
    v_add_u32 v107, 0x10000, v103
    v_lshlrev_b32 v12, 11, v10
    v_lshl_add_u32 v12, v11, 4, v12
    v_add_u32 v108, s67, v12
    v_add_u32 v109, 0x10000, v108
    v_mov_b32 v110, 0xff800000
    s_barrier
    s_waitcnt vmcnt(0)
    v_lshlrev_b32 v24, 16, v16
    v_and_b32 v25, 0xffff0000, v16
    v_lshlrev_b32 v26, 16, v17
    v_and_b32 v27, 0xffff0000, v17
    v_lshlrev_b32 v28, 16, v18
    v_and_b32 v29, 0xffff0000, v18
    v_lshlrev_b32 v30, 16, v19
    v_and_b32 v31, 0xffff0000, v19
    v_lshlrev_b32 v32, 16, v20
    v_and_b32 v33, 0xffff0000, v20
    v_lshlrev_b32 v34, 16, v21
    v_and_b32 v35, 0xffff0000, v21
    v_lshlrev_b32 v36, 16, v22
    v_and_b32 v37, 0xffff0000, v22
    v_lshlrev_b32 v38, 16, v23
    v_and_b32 v39, 0xffff0000, v23
    v_pk_add_f32 v[4:5], v[24:25], v[26:27]
    v_pk_add_f32 v[6:7], v[28:29], v[30:31]
    v_pk_add_f32 v[4:5], v[4:5], v[32:33]
    v_pk_add_f32 v[6:7], v[6:7], v[34:35]
    v_pk_add_f32 v[4:5], v[4:5], v[36:37]
    v_pk_add_f32 v[6:7], v[6:7], v[38:39]
    v_pk_add_f32 v[4:5], v[4:5], v[6:7]
    v_add_f32 v4, v4, v5
    v_mul_f32 v4, v4, v40
    s_nop 1
    v_add_f32_dpp v4, v4, v4 row_ror:8 row_mask:0xf bank_mask:0xf
    s_nop 1
    v_add_f32_dpp v4, v4, v4 row_ror:4 row_mask:0xf bank_mask:0xf
    s_nop 1
    v_add_f32_dpp v4, v4, v4 row_ror:2 row_mask:0xf bank_mask:0xf
    s_nop 1
    v_add_f32_dpp v4, v4, v4 row_ror:1 row_mask:0xf bank_mask:0xf
    v_mov_b32 v5, v4
    s_nop 1
    v_permlane16_swap_b32 v4, v5
    v_add_f32 v4, v4, v5
    v_mul_f32 v6, 0x3b124925, v4
    v_pk_add_f32 v[8:9], v[24:25], v[6:7] op_sel_hi:[1,0] neg_lo:[0,1] neg_hi:[0,1]
    v_pk_mul_f32 v[4:5], v[8:9], v[8:9]
    v_pk_add_f32 v[10:11], v[26:27], v[6:7] op_sel_hi:[1,0] neg_lo:[0,1] neg_hi:[0,1]
    v_pk_fma_f32 v[4:5], v[10:11], v[10:11], v[4:5]
    v_pk_add_f32 v[8:9], v[28:29], v[6:7] op_sel_hi:[1,0] neg_lo:[0,1] neg_hi:[0,1]
    v_pk_fma_f32 v[4:5], v[8:9], v[8:9], v[4:5]
    v_pk_add_f32 v[10:11], v[30:31], v[6:7] op_sel_hi:[1,0] neg_lo:[0,1] neg_hi:[0,1]
    v_pk_fma_f32 v[4:5], v[10:11], v[10:11], v[4:5]
    v_pk_add_f32 v[8:9], v[32:33], v[6:7] op_sel_hi:[1,0] neg_lo:[0,1] neg_hi:[0,1]
    v_pk_fma_f32 v[4:5], v[8:9], v[8:9], v[4:5]
    v_pk_add_f32 v[10:11], v[34:35], v[6:7] op_sel_hi:[1,0] neg_lo:[0,1] neg_hi:[0,1]
    v_pk_fma_f32 v[4:5], v[10:11], v[10:11], v[4:5]
    v_pk_add_f32 v[8:9], v[36:37], v[6:7] op_sel_hi:[1,0] neg_lo:[0,1] neg_hi:[0,1]
    v_pk_fma_f32 v[4:5], v[8:9], v[8:9], v[4:5]
    v_pk_add_f32 v[10:11], v[38:39], v[6:7] op_sel_hi:[1,0] neg_lo:[0,1] neg_hi:[0,1]
    v_pk_fma_f32 v[4:5], v[10:11], v[10:11], v[4:5]
    v_add_f32 v4, v4, v5
    v_mul_f32 v4, v4, v40
    v_cvt_pk_bf16_f32 v6, v6, v6
    v_lshlrev_b32 v6, 16, v6
    v_add_f32_dpp v4, v4, v4 row_ror:8 row_mask:0xf bank_mask:0xf
    s_nop 1
    v_add_f32_dpp v4, v4, v4 row_ror:4 row_mask:0xf bank_mask:0xf
    s_nop 1
    v_add_f32_dpp v4, v4, v4 row_ror:2 row_mask:0xf bank_mask:0xf
    s_nop 1
    v_add_f32_dpp v4, v4, v4 row_ror:1 row_mask:0xf bank_mask:0xf
    v_mov_b32 v5, v4
    s_nop 1
    v_permlane16_swap_b32 v4, v5
    v_add_f32 v4, v4, v5
    v_mul_f32 v4, 0x3b124925, v4
    v_cvt_pk_bf16_f32 v4, v4, v4
    v_lshlrev_b32 v4, 16, v4
    v_add_f32 v4, 0x3727c5ac, v4
    v_cvt_pk_bf16_f32 v4, v4, v4
    v_lshlrev_b32 v4, 16, v4
    v_sqrt_f32 v4, v4
    v_pk_add_f32 v[24:25], v[24:25], v[6:7] op_sel_hi:[1,0] neg_lo:[0,1] neg_hi:[0,1]
    v_pk_add_f32 v[26:27], v[26:27], v[6:7] op_sel_hi:[1,0] neg_lo:[0,1] neg_hi:[0,1]
    v_pk_add_f32 v[28:29], v[28:29], v[6:7] op_sel_hi:[1,0] neg_lo:[0,1] neg_hi:[0,1]
    v_pk_add_f32 v[30:31], v[30:31], v[6:7] op_sel_hi:[1,0] neg_lo:[0,1] neg_hi:[0,1]
    v_pk_add_f32 v[32:33], v[32:33], v[6:7] op_sel_hi:[1,0] neg_lo:[0,1] neg_hi:[0,1]
    v_pk_add_f32 v[34:35], v[34:35], v[6:7] op_sel_hi:[1,0] neg_lo:[0,1] neg_hi:[0,1]
    v_pk_add_f32 v[36:37], v[36:37], v[6:7] op_sel_hi:[1,0] neg_lo:[0,1] neg_hi:[0,1]
    v_pk_add_f32 v[38:39], v[38:39], v[6:7] op_sel_hi:[1,0] neg_lo:[0,1] neg_hi:[0,1]
    v_cvt_pk_bf16_f32 v4, v4, v4
    v_lshlrev_b32 v4, 16, v4
    v_rcp_f32 v4, v4
    v_cvt_pk_bf16_f32 v16, v24, v25
    v_cvt_pk_bf16_f32 v17, v26, v27
    v_cvt_pk_bf16_f32 v18, v28, v29
    v_cvt_pk_bf16_f32 v19, v30, v31
    v_cvt_pk_bf16_f32 v20, v32, v33
    v_cvt_pk_bf16_f32 v21, v34, v35
    v_cvt_pk_bf16_f32 v22, v36, v37
    v_cvt_pk_bf16_f32 v23, v38, v39
    v_lshlrev_b32 v24, 16, v16
    v_and_b32 v25, 0xffff0000, v16
    v_lshlrev_b32 v26, 16, v17
    v_and_b32 v27, 0xffff0000, v17
    v_lshlrev_b32 v28, 16, v18
    v_and_b32 v29, 0xffff0000, v18
    v_lshlrev_b32 v30, 16, v19
    v_and_b32 v31, 0xffff0000, v19
    v_lshlrev_b32 v32, 16, v20
    v_and_b32 v33, 0xffff0000, v20
    v_lshlrev_b32 v34, 16, v21
    v_and_b32 v35, 0xffff0000, v21
    v_lshlrev_b32 v36, 16, v22
    v_and_b32 v37, 0xffff0000, v22
    v_lshlrev_b32 v38, 16, v23
    v_and_b32 v39, 0xffff0000, v23
    v_pk_mul_f32 v[24:25], v[24:25], v[4:5] op_sel_hi:[1,0]
    v_pk_mul_f32 v[26:27], v[26:27], v[4:5] op_sel_hi:[1,0]
    v_pk_mul_f32 v[28:29], v[28:29], v[4:5] op_sel_hi:[1,0]
    v_pk_mul_f32 v[30:31], v[30:31], v[4:5] op_sel_hi:[1,0]
    v_pk_mul_f32 v[32:33], v[32:33], v[4:5] op_sel_hi:[1,0]
    v_pk_mul_f32 v[34:35], v[34:35], v[4:5] op_sel_hi:[1,0]
    v_pk_mul_f32 v[36:37], v[36:37], v[4:5] op_sel_hi:[1,0]
    v_pk_mul_f32 v[38:39], v[38:39], v[4:5] op_sel_hi:[1,0]
    v_cvt_pk_bf16_f32 v16, v24, v25
    v_cvt_pk_bf16_f32 v17, v26, v27
    v_cvt_pk_bf16_f32 v18, v28, v29
    v_cvt_pk_bf16_f32 v19, v30, v31
    v_cvt_pk_bf16_f32 v20, v32, v33
    v_cvt_pk_bf16_f32 v21, v34, v35
    v_cvt_pk_bf16_f32 v22, v36, v37
    v_cvt_pk_bf16_f32 v23, v38, v39
    s_mov_b64 exec, s[70:71]
    ds_write_b128 v41, v[16:19] offset:0
    ds_write_b128 v41, v[20:23] offset:448
    s_mov_b64 exec, -1
    s_waitcnt lgkmcnt(0)
    ds_write_b32 v15, v14 offset:32
    s_cmp_ge_u32 s32, 14
    s_cbranch_scc1 L_noln2
    v_lshlrev_b32 v24, 16, v16
    v_and_b32 v25, 0xffff0000, v16
    v_lshlrev_b32 v26, 16, v17
    v_and_b32 v27, 0xffff0000, v17
    v_lshlrev_b32 v28, 16, v18
    v_and_b32 v29, 0xffff0000, v18
    v_lshlrev_b32 v30, 16, v19
    v_and_b32 v31, 0xffff0000, v19
    v_lshlrev_b32 v32, 16, v20
    v_and_b32 v33, 0xffff0000, v20
    v_lshlrev_b32 v34, 16, v21
    v_and_b32 v35, 0xffff0000, v21
    v_lshlrev_b32 v36, 16, v22
    v_and_b32 v37, 0xffff0000, v22
    v_lshlrev_b32 v38, 16, v23
    v_and_b32 v39, 0xffff0000, v23
    v_pk_add_f32 v[4:5], v[24:25], v[26:27]
    v_pk_add_f32 v[6:7], v[28:29], v[30:31]
    v_pk_add_f32 v[4:5], v[4:5], v[32:33]
    v_pk_add_f32 v[6:7], v[6:7], v[34:35]
    v_pk_add_f32 v[4:5], v[4:5], v[36:37]
    v_pk_add_f32 v[6:7], v[6:7], v[38:39]
    v_pk_add_f32 v[4:5], v[4:5], v[6:7]
    v_add_f32 v4, v4, v5
    v_mul_f32 v4, v4, v40
    s_nop 1
    v_add_f32_dpp v4, v4, v4 row_ror:8 row_mask:0xf bank_mask:0xf
    s_nop 1
    v_add_f32_dpp v4, v4, v4 row_ror:4 row_mask:0xf bank_mask:0xf
    s_nop 1
    v_add_f32_dpp v4, v4, v4 row_ror:2 row_mask:0xf bank_mask:0xf
    s_nop 1
    v_add_f32_dpp v4, v4, v4 row_ror:1 row_mask:0xf bank_mask:0xf
    v_mov_b32 v5, v4
    s_nop 1
    v_permlane16_swap_b32 v4, v5
    v_add_f32 v4, v4, v5
    v_mul_f32 v6, 0x3b124925, v4
    v_pk_add_f32 v[8:9], v[24:25], v[6:7] op_sel_hi:[1,0] neg_lo:[0,1] neg_hi:[0,1]
    v_pk_mul_f32 v[4:5], v[8:9], v[8:9]
    v_pk_add_f32 v[10:11], v[26:27], v[6:7] op_sel_hi:[1,0] neg_lo:[0,1] neg_hi:[0,1]
    v_pk_fma_f32 v[4:5], v[10:11], v[10:11], v[4:5]
    v_pk_add_f32 v[8:9], v[28:29], v[6:7] op_sel_hi:[1,0] neg_lo:[0,1] neg_hi:[0,1]
    v_pk_fma_f32 v[4:5], v[8:9], v[8:9], v[4:5]
    v_pk_add_f32 v[10:11], v[30:31], v[6:7] op_sel_hi:[1,0] neg_lo:[0,1] neg_hi:[0,1]
    v_pk_fma_f32 v[4:5], v[10:11], v[10:11], v[4:5]
    v_pk_add_f32 v[8:9], v[32:33], v[6:7] op_sel_hi:[1,0] neg_lo:[0,1] neg_hi:[0,1]
    v_pk_fma_f32 v[4:5], v[8:9], v[8:9], v[4:5]
    v_pk_add_f32 v[10:11], v[34:35], v[6:7] op_sel_hi:[1,0] neg_lo:[0,1] neg_hi:[0,1]
    v_pk_fma_f32 v[4:5], v[10:11], v[10:11], v[4:5]
    v_pk_add_f32 v[8:9], v[36:37], v[6:7] op_sel_hi:[1,0] neg_lo:[0,1] neg_hi:[0,1]
    v_pk_fma_f32 v[4:5], v[8:9], v[8:9], v[4:5]
    v_pk_add_f32 v[10:11], v[38:39], v[6:7] op_sel_hi:[1,0] neg_lo:[0,1] neg_hi:[0,1]
    v_pk_fma_f32 v[4:5], v[10:11], v[10:11], v[4:5]
    v_add_f32 v4, v4, v5
    v_mul_f32 v4, v4, v40
    v_cvt_pk_bf16_f32 v6, v6, v6
    v_lshlrev_b32 v6, 16, v6
    v_add_f32_dpp v4, v4, v4 row_ror:8 row_mask:0xf bank_mask:0xf
    s_nop 1
    v_add_f32_dpp v4, v4, v4 row_ror:4 row_mask:0xf bank_mask:0xf
    s_nop 1
    v_add_f32_dpp v4, v4, v4 row_ror:2 row_mask:0xf bank_mask:0xf
    s_nop 1
    v_add_f32_dpp v4, v4, v4 row_ror:1 row_mask:0xf bank_mask:0xf
    v_mov_b32 v5, v4
    s_nop 1
    v_permlane16_swap_b32 v4, v5
    v_add_f32 v4, v4, v5
    v_mul_f32 v4, 0x3b124925, v4
    v_cvt_pk_bf16_f32 v4, v4, v4
    v_lshlrev_b32 v4, 16, v4
    v_add_f32 v4, 0x3727c5ac, v4
    v_cvt_pk_bf16_f32 v4, v4, v4
    v_lshlrev_b32 v4, 16, v4
    v_sqrt_f32 v4, v4
    v_pk_add_f32 v[24:25], v[24:25], v[6:7] op_sel_hi:[1,0] neg_lo:[0,1] neg_hi:[0,1]
    v_pk_add_f32 v[26:27], v[26:27], v[6:7] op_sel_hi:[1,0] neg_lo:[0,1] neg_hi:[0,1]
    v_pk_add_f32 v[28:29], v[28:29], v[6:7] op_sel_hi:[1,0] neg_lo:[0,1] neg_hi:[0,1]
    v_pk_add_f32 v[30:31], v[30:31], v[6:7] op_sel_hi:[1,0] neg_lo:[0,1] neg_hi:[0,1]
    v_pk_add_f32 v[32:33], v[32:33], v[6:7] op_sel_hi:[1,0] neg_lo:[0,1] neg_hi:[0,1]
    v_pk_add_f32 v[34:35], v[34:35], v[6:7] op_sel_hi:[1,0] neg_lo:[0,1] neg_hi:[0,1]
    v_pk_add_f32 v[36:37], v[36:37], v[6:7] op_sel_hi:[1,0] neg_lo:[0,1] neg_hi:[0,1]
    v_pk_add_f32 v[38:39], v[38:39], v[6:7] op_sel_hi:[1,0] neg_lo:[0,1] neg_hi:[0,1]
    v_cvt_pk_bf16_f32 v4, v4, v4
    v_lshlrev_b32 v4, 16, v4
    v_rcp_f32 v4, v4
    v_cvt_pk_bf16_f32 v16, v24, v25
    v_cvt_pk_bf16_f32 v17, v26, v27
    v_cvt_pk_bf16_f32 v18, v28, v29
    v_cvt_pk_bf16_f32 v19, v30, v31
    v_cvt_pk_bf16_f32 v20, v32, v33
    v_cvt_pk_bf16_f32 v21, v34, v35
    v_cvt_pk_bf16_f32 v22, v36, v37
    v_cvt_pk_bf16_f32 v23, v38, v39
    v_lshlrev_b32 v24, 16, v16
    v_and_b32 v25, 0xffff0000, v16
    v_lshlrev_b32 v26, 16, v17
    v_and_b32 v27, 0xffff0000, v17
    v_lshlrev_b32 v28, 16, v18
    v_and_b32 v29, 0xffff0000, v18
    v_lshlrev_b32 v30, 16, v19
    v_and_b32 v31, 0xffff0000, v19
    v_lshlrev_b32 v32, 16, v20
    v_and_b32 v33, 0xffff0000, v20
    v_lshlrev_b32 v34, 16, v21
    v_and_b32 v35, 0xffff0000, v21
    v_lshlrev_b32 v36, 16, v22
    v_and_b32 v37, 0xffff0000, v22
    v_lshlrev_b32 v38, 16, v23
    v_and_b32 v39, 0xffff0000, v23
    v_pk_mul_f32 v[24:25], v[24:25], v[4:5] op_sel_hi:[1,0]
    v_pk_mul_f32 v[26:27], v[26:27], v[4:5] op_sel_hi:[1,0]
    v_pk_mul_f32 v[28:29], v[28:29], v[4:5] op_sel_hi:[1,0]
    v_pk_mul_f32 v[30:31], v[30:31], v[4:5] op_sel_hi:[1,0]
    v_pk_mul_f32 v[32:33], v[32:33], v[4:5] op_sel_hi:[1,0]
    v_pk_mul_f32 v[34:35], v[34:35], v[4:5] op_sel_hi:[1,0]
    v_pk_mul_f32 v[36:37], v[36:37], v[4:5] op_sel_hi:[1,0]
    v_pk_mul_f32 v[38:39], v[38:39], v[4:5] op_sel_hi:[1,0]
    v_cvt_pk_bf16_f32 v16, v24, v25
    v_cvt_pk_bf16_f32 v17, v26, v27
    v_cvt_pk_bf16_f32 v18, v28, v29
    v_cvt_pk_bf16_f32 v19, v30, v31
    v_cvt_pk_bf16_f32 v20, v32, v33
    v_cvt_pk_bf16_f32 v21, v34, v35
    v_cvt_pk_bf16_f32 v22, v36, v37
    v_cvt_pk_bf16_f32 v23, v38, v39
    s_mov_b64 exec, s[70:71]
    ds_write_b128 v41, v[16:19] offset:7296
    ds_write_b128 v41, v[20:23] offset:7744
    s_mov_b64 exec, -1
    ds_write_b32 v15, v14 offset:64
L_noln2:
    s_waitcnt lgkmcnt(0)
    s_add_u32 s64, s64, 1
    s_add_u32 s67, s23, 0
    s_cmp_gt_i32 s65, s67
    s_cbranch_scc1 L_wtok_42
L_wt_41:
    ds_read_b32 v4, v1 offset:0
    s_waitcnt lgkmcnt(0)
    v_readfirstlane_b32 s65, v4
    s_nop 0
    s_cmp_gt_i32 s65, s67
    s_cbranch_scc1 L_wtok_42
    s_sub_u32 s66, s66, 1
    s_cbranch_scc1 L_end
    s_branch L_wt_41
L_wtok_42:
    ds_read_b128 a[32:35], v100 offset:0
    ds_read_b128 a[36:39], v101 offset:0
    ds_read_b128 a[40:43], v102 offset:0
    ds_read_b128 a[44:47], v103 offset:0
    ds_read_b128 a[48:51], v100 offset:256
    ds_read_b128 a[52:55], v101 offset:256
    ds_read_b128 a[56:59], v102 offset:256
    ds_read_b128 a[60:63], v103 offset:256
    v_mov_b32 v5, 1
    s_waitcnt lgkmcnt(0)
    ds_write_b32 v15, v5 offset:16
    s_add_u32 s67, s23, 4
    s_cmp_gt_i32 s65, s67
    s_cbranch_scc1 L_wtok_44
L_wt_43:
    ds_read_b32 v4, v1 offset:0
    s_waitcnt lgkmcnt(0)
    v_readfirstlane_b32 s65, v4
    s_nop 0
    s_cmp_gt_i32 s65, s67
    s_cbranch_scc1 L_wtok_44
    s_sub_u32 s66, s66, 1
    s_cbranch_scc1 L_end
    s_branch L_wt_43
L_wtok_44:
    ds_read_b128 a[64:67], v100 offset:32768
    ds_read_b128 a[68:71], v101 offset:32768
    ds_read_b128 a[72:75], v102 offset:32768
    ds_read_b128 a[76:79], v103 offset:32768
    ds_read_b128 a[80:83], v100 offset:33024
    ds_read_b128 a[84:87], v101 offset:33024
    ds_read_b128 a[88:91], v102 offset:33024
    ds_read_b128 a[92:95], v103 offset:33024
    v_mov_b32 v5, 2
    s_waitcnt lgkmcnt(0)
    ds_write_b32 v15, v5 offset:16
    s_add_u32 s67, s23, 8
    s_cmp_gt_i32 s65, s67
    s_cbranch_scc1 L_wtok_46
L_wt_45:
    ds_read_b32 v4, v1 offset:0
    s_waitcnt lgkmcnt(0)
    v_readfirstlane_b32 s65, v4
    s_nop 0
    s_cmp_gt_i32 s65, s67
    s_cbranch_scc1 L_wtok_46
    s_sub_u32 s66, s66, 1
    s_cbranch_scc1 L_end
    s_branch L_wt_45
L_wtok_46:
    ds_read_b128 a[96:99], v104 offset:0
    ds_read_b128 a[100:103], v105 offset:0
    ds_read_b128 a[104:107], v106 offset:0
    ds_read_b128 a[108:111], v107 offset:0
    ds_read_b128 a[112:115], v104 offset:256
    ds_read_b128 a[116:119], v105 offset:256
    ds_read_b128 a[120:123], v106 offset:256
    ds_read_b128 a[124:127], v107 offset:256
    v_mov_b32 v5, 3
    s_waitcnt lgkmcnt(0)
    ds_write_b32 v15, v5 offset:16
    s_add_u32 s67, s23, 12
    s_cmp_gt_i32 s65, s67
    s_cbranch_scc1 L_wtok_48
L_wt_47:
    ds_read_b32 v4, v1 offset:0
    s_waitcnt lgkmcnt(0)
    v_readfirstlane_b32 s65, v4
    s_nop 0
    s_cmp_gt_i32 s65, s67
    s_cbranch_scc1 L_wtok_48
    s_sub_u32 s66, s66, 1
    s_cbranch_scc1 L_end
    s_branch L_wt_47
L_wtok_48:
    ds_read_b128 v[48:51], v104 offset:32768
    ds_read_b128 v[52:55], v105 offset:32768
    ds_read_b128 v[56:59], v106 offset:32768
    ds_read_b128 v[60:63], v107 offset:32768
    ds_read_b128 v[64:67], v104 offset:33024
    ds_read_b128 v[68:71], v105 offset:33024
    ds_read_b128 v[72:75], v106 offset:33024
    ds_read_b128 v[76:79], v107 offset:33024
    v_mov_b32 v5, 4
    s_waitcnt lgkmcnt(0)
    ds_write_b32 v15, v5 offset:16
L_wf_49:
    ds_read_b32 v4, v1 offset:48
    s_waitcnt lgkmcnt(0)
    v_readfirstlane_b32 s67, v4
    s_nop 0
    s_cmp_lg_u32 s67, 0
    s_cbranch_scc1 L_wfok_50
    s_sub_u32 s66, s66, 1
    s_cbranch_scc1 L_end
    s_branch L_wf_49
L_wfok_50:
    v_bfe_u32 v10, v0, 3, 1
    v_lshrrev_b32 v11, 4, v0
    v_lshlrev_b32 v10, 9, v10
    v_lshl_add_u32 v10, v11, 4, v10
    v_add_u32 v10, 132096, v10
    ds_read_b128 a[0:3], v10 offset:0
    ds_read_b128 a[4:7], v10 offset:64
    ds_read_b128 a[8:11], v10 offset:128
    ds_read_b128 a[12:15], v10 offset:192
    ds_read_b128 a[16:19], v10 offset:256
    ds_read_b128 a[20:23], v10 offset:320
    ds_read_b128 a[24:27], v10 offset:384
    ds_read_b128 a[28:31], v10 offset:448
    s_waitcnt lgkmcnt(7)
    v_mfma_f32_16x16x32_bf16 v[96:99], a[32:35], a[0:3], 0
    s_waitcnt lgkmcnt(6)
    v_mfma_f32_16x16x32_bf16 v[96:99], a[36:39], a[4:7], v[96:99]
    s_waitcnt lgkmcnt(5)
    v_mfma_f32_16x16x32_bf16 v[96:99], a[40:43], a[8:11], v[96:99]
    s_waitcnt lgkmcnt(4)
    v_mfma_f32_16x16x32_bf16 v[96:99], a[44:47], a[12:15], v[96:99]
    s_waitcnt lgkmcnt(3)
    v_mfma_f32_16x16x32_bf16 v[96:99], a[48:51], a[16:19], v[96:99]
    s_waitcnt lgkmcnt(2)
    v_mfma_f32_16x16x32_bf16 v[96:99], a[52:55], a[20:23], v[96:99]
    s_waitcnt lgkmcnt(1)
    v_mfma_f32_16x16x32_bf16 v[96:99], a[56:59], a[24:27], v[96:99]
    s_waitcnt lgkmcnt(0)
    v_mfma_f32_16x16x32_bf16 v[96:99], a[60:63], a[28:31], v[96:99]
    s_nop 7
    v_max3_f32 v110, v110, v96, v97
    v_max3_f32 v110, v110, v98, v99
    v_cvt_pk_bf16_f32 v16, v96, v97
    v_cvt_pk_bf16_f32 v17, v98, v99
    v_mfma_f32_16x16x32_bf16 v[96:99], a[64:67], a[0:3], 0
    v_mfma_f32_16x16x32_bf16 v[96:99], a[68:71], a[4:7], v[96:99]
    v_mfma_f32_16x16x32_bf16 v[96:99], a[72:75], a[8:11], v[96:99]
    v_mfma_f32_16x16x32_bf16 v[96:99], a[76:79], a[12:15], v[96:99]
    v_mfma_f32_16x16x32_bf16 v[96:99], a[80:83], a[16:19], v[96:99]
    v_mfma_f32_16x16x32_bf16 v[96:99], a[84:87], a[20:23], v[96:99]
    v_mfma_f32_16x16x32_bf16 v[96:99], a[88:91], a[24:27], v[96:99]
    v_mfma_f32_16x16x32_bf16 v[96:99], a[92:95], a[28:31], v[96:99]
    s_nop 7
    v_max3_f32 v110, v110, v96, v97
    v_max3_f32 v110, v110, v98, v99
    v_cvt_pk_bf16_f32 v18, v96, v97
    v_cvt_pk_bf16_f32 v19, v98, v99
    v_mfma_f32_16x16x32_bf16 v[96:99], a[96:99], a[0:3], 0
    v_mfma_f32_16x16x32_bf16 v[96:99], a[100:103], a[4:7], v[96:99]
    v_mfma_f32_16x16x32_bf16 v[96:99], a[104:107], a[8:11], v[96:99]
    v_mfma_f32_16x16x32_bf16 v[96:99], a[108:111], a[12:15], v[96:99]
    v_mfma_f32_16x16x32_bf16 v[96:99], a[112:115], a[16:19], v[96:99]
    v_mfma_f32_16x16x32_bf16 v[96:99], a[116:119], a[20:23], v[96:99]
    v_mfma_f32_16x16x32_bf16 v[96:99], a[120:123], a[24:27], v[96:99]
    v_mfma_f32_16x16x32_bf16 v[96:99], a[124:127], a[28:31], v[96:99]
    s_nop 7
    v_max3_f32 v110, v110, v96, v97
    v_max3_f32 v110, v110, v98, v99
    v_cvt_pk_bf16_f32 v20, v96, v97
    v_cvt_pk_bf16_f32 v21, v98, v99
    v_mfma_f32_16x16x32_bf16 v[96:99], v[48:51], a[0:3], 0
    v_mfma_f32_16x16x32_bf16 v[96:99], v[52:55], a[4:7], v[96:99]
    v_mfma_f32_16x16x32_bf16 v[96:99], v[56:59], a[8:11], v[96:99]
    v_mfma_f32_16x16x32_bf16 v[96:99], v[60:63], a[12:15], v[96:99]
    v_mfma_f32_16x16x32_bf16 v[96:99], v[64:67], a[16:19], v[96:99]
    v_mfma_f32_16x16x32_bf16 v[96:99], v[68:71], a[20:23], v[96:99]
    v_mfma_f32_16x16x32_bf16 v[96:99], v[72:75], a[24:27], v[96:99]
    v_mfma_f32_16x16x32_bf16 v[96:99], v[76:79], a[28:31], v[96:99]
    s_nop 7
    v_max3_f32 v110, v110, v96, v97
    v_max3_f32 v110, v110, v98, v99
    v_cvt_pk_bf16_f32 v22, v96, v97
    v_cvt_pk_bf16_f32 v23, v98, v99
    s_add_u32 s67, s23, 16
    s_cmp_gt_i32 s65, s67
    s_cbranch_scc1 L_wtok_52
L_wt_51:
    ds_read_b32 v4, v1 offset:0
    s_waitcnt lgkmcnt(0)
    v_readfirstlane_b32 s65, v4
    s_nop 0
    s_cmp_gt_i32 s65, s67
    s_cbranch_scc1 L_wtok_52
    s_sub_u32 s66, s66, 1
    s_cbranch_scc1 L_end
    s_branch L_wt_51
L_wtok_52:
    ds_read_b128 v[48:51], v100 offset:0
    ds_read_b128 v[52:55], v101 offset:0
    ds_read_b128 v[56:59], v102 offset:0
    ds_read_b128 v[60:63], v103 offset:0
    ds_read_b128 v[64:67], v100 offset:256
    ds_read_b128 v[68:71], v101 offset:256
    ds_read_b128 v[72:75], v102 offset:256
    ds_read_b128 v[76:79], v103 offset:256
    v_mov_b32 v5, 5
    s_waitcnt lgkmcnt(7)
    v_mfma_f32_16x16x32_bf16 v[96:99], v[48:51], a[0:3], 0
    s_waitcnt lgkmcnt(6)
    v_mfma_f32_16x16x32_bf16 v[96:99], v[52:55], a[4:7], v[96:99]
    s_waitcnt lgkmcnt(5)
    v_mfma_f32_16x16x32_bf16 v[96:99], v[56:59], a[8:11], v[96:99]
    s_waitcnt lgkmcnt(4)
    v_mfma_f32_16x16x32_bf16 v[96:99], v[60:63], a[12:15], v[96:99]
    s_waitcnt lgkmcnt(3)
    v_mfma_f32_16x16x32_bf16 v[96:99], v[64:67], a[16:19], v[96:99]
    s_waitcnt lgkmcnt(2)
    v_mfma_f32_16x16x32_bf16 v[96:99], v[68:71], a[20:23], v[96:99]
    s_waitcnt lgkmcnt(1)
    v_mfma_f32_16x16x32_bf16 v[96:99], v[72:75], a[24:27], v[96:99]
    s_waitcnt lgkmcnt(0)
    ds_write_b32 v15, v5 offset:16
    v_mfma_f32_16x16x32_bf16 v[96:99], v[76:79], a[28:31], v[96:99]
    s_nop 7
    v_max3_f32 v110, v110, v96, v97
    v_max3_f32 v110, v110, v98, v99
    v_cvt_pk_bf16_f32 v24, v96, v97
    v_cvt_pk_bf16_f32 v25, v98, v99
    s_add_u32 s67, s23, 20
    s_cmp_gt_i32 s65, s67
    s_cbranch_scc1 L_wtok_54
L_wt_53:
    ds_read_b32 v4, v1 offset:0
    s_waitcnt lgkmcnt(0)
    v_readfirstlane_b32 s65, v4
    s_nop 0
    s_cmp_gt_i32 s65, s67
    s_cbranch_scc1 L_wtok_54
    s_sub_u32 s66, s66, 1
    s_cbranch_scc1 L_end
    s_branch L_wt_53
L_wtok_54:
    ds_read_b128 v[48:51], v100 offset:32768
    ds_read_b128 v[52:55], v101 offset:32768
    ds_read_b128 v[56:59], v102 offset:32768
    ds_read_b128 v[60:63], v103 offset:32768
    ds_read_b128 v[64:67], v100 offset:33024
    ds_read_b128 v[68:71], v101 offset:33024
    ds_read_b128 v[72:75], v102 offset:33024
    ds_read_b128 v[76:79], v103 offset:33024
    v_mov_b32 v5, 6
    s_waitcnt lgkmcnt(7)
    v_mfma_f32_16x16x32_bf16 v[96:99], v[48:51], a[0:3], 0
    s_waitcnt lgkmcnt(6)
    v_mfma_f32_16x16x32_bf16 v[96:99], v[52:55], a[4:7], v[96:99]
    s_waitcnt lgkmcnt(5)
    v_mfma_f32_16x16x32_bf16 v[96:99], v[56:59], a[8:11], v[96:99]
    s_waitcnt lgkmcnt(4)
    v_mfma_f32_16x16x32_bf16 v[96:99], v[60:63], a[12:15], v[96:99]
    s_waitcnt lgkmcnt(3)
    v_mfma_f32_16x16x32_bf16 v[96:99], v[64:67], a[16:19], v[96:99]
    s_waitcnt lgkmcnt(2)
    v_mfma_f32_16x16x32_bf16 v[96:99], v[68:71], a[20:23], v[96:99]
    s_waitcnt lgkmcnt(1)
    v_mfma_f32_16x16x32_bf16 v[96:99], v[72:75], a[24:27], v[96:99]
    s_waitcnt lgkmcnt(0)
    ds_write_b32 v15, v5 offset:16
    v_mfma_f32_16x16x32_bf16 v[96:99], v[76:79], a[28:31], v[96:99]
    s_nop 7
    v_max3_f32 v110, v110, v96, v97
    v_max3_f32 v110, v110, v98, v99
    v_cvt_pk_bf16_f32 v26, v96, v97
    v_cvt_pk_bf16_f32 v27, v98, v99
    s_add_u32 s67, s23, 24
    s_cmp_gt_i32 s65, s67
    s_cbranch_scc1 L_wtok_56
L_wt_55:
    ds_read_b32 v4, v1 offset:0
    s_waitcnt lgkmcnt(0)
    v_readfirstlane_b32 s65, v4
    s_nop 0
    s_cmp_gt_i32 s65, s67
    s_cbranch_scc1 L_wtok_56
    s_sub_u32 s66, s66, 1
    s_cbranch_scc1 L_end
    s_branch L_wt_55
L_wtok_56:
    ds_read_b128 v[48:51], v104 offset:0
    ds_read_b128 v[52:55], v105 offset:0
    ds_read_b128 v[56:59], v106 offset:0
    ds_read_b128 v[60:63], v107 offset:0
    ds_read_b128 v[64:67], v104 offset:256
    ds_read_b128 v[68:71], v105 offset:256
    ds_read_b128 v[72:75], v106 offset:256
    ds_read_b128 v[76:79], v107 offset:256
    v_mov_b32 v5, 7
    s_waitcnt lgkmcnt(7)
    v_mfma_f32_16x16x32_bf16 v[96:99], v[48:51], a[0:3], 0
    s_waitcnt lgkmcnt(6)
    v_mfma_f32_16x16x32_bf16 v[96:99], v[52:55], a[4:7], v[96:99]
    s_waitcnt lgkmcnt(5)
    v_mfma_f32_16x16x32_bf16 v[96:99], v[56:59], a[8:11], v[96:99]
    s_waitcnt lgkmcnt(4)
    v_mfma_f32_16x16x32_bf16 v[96:99], v[60:63], a[12:15], v[96:99]
    s_waitcnt lgkmcnt(3)
    v_mfma_f32_16x16x32_bf16 v[96:99], v[64:67], a[16:19], v[96:99]
    s_waitcnt lgkmcnt(2)
    v_mfma_f32_16x16x32_bf16 v[96:99], v[68:71], a[20:23], v[96:99]
    s_waitcnt lgkmcnt(1)
    v_mfma_f32_16x16x32_bf16 v[96:99], v[72:75], a[24:27], v[96:99]
    s_waitcnt lgkmcnt(0)
    ds_write_b32 v15, v5 offset:16
    v_mfma_f32_16x16x32_bf16 v[96:99], v[76:79], a[28:31], v[96:99]
    s_nop 7
    v_max3_f32 v110, v110, v96, v97
    v_max3_f32 v110, v110, v98, v99
    v_cvt_pk_bf16_f32 v28, v96, v97
    v_cvt_pk_bf16_f32 v29, v98, v99
    s_add_u32 s67, s23, 28
    s_cmp_gt_i32 s65, s67
    s_cbranch_scc1 L_wtok_58
L_wt_57:
    ds_read_b32 v4, v1 offset:0
    s_waitcnt lgkmcnt(0)
    v_readfirstlane_b32 s65, v4
    s_nop 0
    s_cmp_gt_i32 s65, s67
    s_cbranch_scc1 L_wtok_58
    s_sub_u32 s66, s66, 1
    s_cbranch_scc1 L_end
    s_branch L_wt_57
L_wtok_58:
    ds_read_b128 v[48:51], v104 offset:32768
    ds_read_b128 v[52:55], v105 offset:32768
    ds_read_b128 v[56:59], v106 offset:32768
    ds_read_b128 v[60:63], v107 offset:32768
    ds_read_b128 v[64:67], v104 offset:33024
    ds_read_b128 v[68:71], v105 offset:33024
    ds_read_b128 v[72:75], v106 offset:33024
    ds_read_b128 v[76:79], v107 offset:33024
    v_mov_b32 v5, 8
    s_waitcnt lgkmcnt(7)
    v_mfma_f32_16x16x32_bf16 v[96:99], v[48:51], a[0:3], 0
    s_waitcnt lgkmcnt(6)
    v_mfma_f32_16x16x32_bf16 v[96:99], v[52:55], a[4:7], v[96:99]
    s_waitcnt lgkmcnt(5)
    v_mfma_f32_16x16x32_bf16 v[96:99], v[56:59], a[8:11], v[96:99]
    s_waitcnt lgkmcnt(4)
    v_mfma_f32_16x16x32_bf16 v[96:99], v[60:63], a[12:15], v[96:99]
    s_waitcnt lgkmcnt(3)
    v_mfma_f32_16x16x32_bf16 v[96:99], v[64:67], a[16:19], v[96:99]
    s_waitcnt lgkmcnt(2)
    v_mfma_f32_16x16x32_bf16 v[96:99], v[68:71], a[20:23], v[96:99]
    s_waitcnt lgkmcnt(1)
    v_mfma_f32_16x16x32_bf16 v[96:99], v[72:75], a[24:27], v[96:99]
    s_waitcnt lgkmcnt(0)
    ds_write_b32 v15, v5 offset:16
    v_mfma_f32_16x16x32_bf16 v[96:99], v[76:79], a[28:31], v[96:99]
    s_nop 7
    v_max3_f32 v110, v110, v96, v97
    v_max3_f32 v110, v110, v98, v99
    v_cvt_pk_bf16_f32 v30, v96, v97
    v_cvt_pk_bf16_f32 v31, v98, v99
    s_add_u32 s67, s23, 32
    s_cmp_gt_i32 s65, s67
    s_cbranch_scc1 L_wtok_60
L_wt_59:
    ds_read_b32 v4, v1 offset:0
    s_waitcnt lgkmcnt(0)
    v_readfirstlane_b32 s65, v4
    s_nop 0
    s_cmp_gt_i32 s65, s67
    s_cbranch_scc1 L_wtok_60
    s_sub_u32 s66, s66, 1
    s_cbranch_scc1 L_end
    s_branch L_wt_59
L_wtok_60:
    ds_read_b128 v[48:51], v100 offset:0
    ds_read_b128 v[52:55], v101 offset:0
    ds_read_b128 v[56:59], v102 offset:0
    ds_read_b128 v[60:63], v103 offset:0
    ds_read_b128 v[64:67], v100 offset:256
    ds_read_b128 v[68:71], v101 offset:256
    ds_read_b128 v[72:75], v102 offset:256
    ds_read_b128 v[76:79], v103 offset:256
    v_mov_b32 v5, 9
    s_waitcnt lgkmcnt(7)
    v_mfma_f32_16x16x32_bf16 v[96:99], v[48:51], a[0:3], 0
    s_waitcnt lgkmcnt(6)
    v_mfma_f32_16x16x32_bf16 v[96:99], v[52:55], a[4:7], v[96:99]
    s_waitcnt lgkmcnt(5)
    v_mfma_f32_16x16x32_bf16 v[96:99], v[56:59], a[8:11], v[96:99]
    s_waitcnt lgkmcnt(4)
    v_mfma_f32_16x16x32_bf16 v[96:99], v[60:63], a[12:15], v[96:99]
    s_waitcnt lgkmcnt(3)
    v_mfma_f32_16x16x32_bf16 v[96:99], v[64:67], a[16:19], v[96:99]
    s_waitcnt lgkmcnt(2)
    v_mfma_f32_16x16x32_bf16 v[96:99], v[68:71], a[20:23], v[96:99]
    s_waitcnt lgkmcnt(1)
    v_mfma_f32_16x16x32_bf16 v[96:99], v[72:75], a[24:27], v[96:99]
    s_waitcnt lgkmcnt(0)
    ds_write_b32 v15, v5 offset:16
    v_mfma_f32_16x16x32_bf16 v[96:99], v[76:79], a[28:31], v[96:99]
    s_nop 7
    v_max3_f32 v110, v110, v96, v97
    v_max3_f32 v110, v110, v98, v99
    v_cvt_pk_bf16_f32 v32, v96, v97
    v_cvt_pk_bf16_f32 v33, v98, v99
    s_add_u32 s67, s23, 36
    s_cmp_gt_i32 s65, s67
    s_cbranch_scc1 L_wtok_62
L_wt_61:
    ds_read_b32 v4, v1 offset:0
    s_waitcnt lgkmcnt(0)
    v_readfirstlane_b32 s65, v4
    s_nop 0
    s_cmp_gt_i32 s65, s67
    s_cbranch_scc1 L_wtok_62
    s_sub_u32 s66, s66, 1
    s_cbranch_scc1 L_end
    s_branch L_wt_61
L_wtok_62:
    ds_read_b128 v[48:51], v100 offset:32768
    ds_read_b128 v[52:55], v101 offset:32768
    ds_read_b128 v[56:59], v102 offset:32768
    ds_read_b128 v[60:63], v103 offset:32768
    ds_read_b128 v[64:67], v100 offset:33024
    ds_read_b128 v[68:71], v101 offset:33024
    ds_read_b128 v[72:75], v102 offset:33024
    ds_read_b128 v[76:79], v103 offset:33024
    v_mov_b32 v5, 10
    s_waitcnt lgkmcnt(7)
    v_mfma_f32_16x16x32_bf16 v[96:99], v[48:51], a[0:3], 0
    s_waitcnt lgkmcnt(6)
    v_mfma_f32_16x16x32_bf16 v[96:99], v[52:55], a[4:7], v[96:99]
    s_waitcnt lgkmcnt(5)
    v_mfma_f32_16x16x32_bf16 v[96:99], v[56:59], a[8:11], v[96:99]
    s_waitcnt lgkmcnt(4)
    v_mfma_f32_16x16x32_bf16 v[96:99], v[60:63], a[12:15], v[96:99]
    s_waitcnt lgkmcnt(3)
    v_mfma_f32_16x16x32_bf16 v[96:99], v[64:67], a[16:19], v[96:99]
    s_waitcnt lgkmcnt(2)
    v_mfma_f32_16x16x32_bf16 v[96:99], v[68:71], a[20:23], v[96:99]
    s_waitcnt lgkmcnt(1)
    v_mfma_f32_16x16x32_bf16 v[96:99], v[72:75], a[24:27], v[96:99]
    s_waitcnt lgkmcnt(0)
    ds_write_b32 v15, v5 offset:16
    v_mfma_f32_16x16x32_bf16 v[96:99], v[76:79], a[28:31], v[96:99]
    s_nop 7
    v_max3_f32 v110, v110, v96, v97
    v_max3_f32 v110, v110, v98, v99
    v_cvt_pk_bf16_f32 v34, v96, v97
    v_cvt_pk_bf16_f32 v35, v98, v99
    s_add_u32 s67, s23, 40
    s_cmp_gt_i32 s65, s67
    s_cbranch_scc1 L_wtok_64
L_wt_63:
    ds_read_b32 v4, v1 offset:0
    s_waitcnt lgkmcnt(0)
    v_readfirstlane_b32 s65, v4
    s_nop 0
    s_cmp_gt_i32 s65, s67
    s_cbranch_scc1 L_wtok_64
    s_sub_u32 s66, s66, 1
    s_cbranch_scc1 L_end
    s_branch L_wt_63
L_wtok_64:
    ds_read_b128 v[48:51], v104 offset:0
    ds_read_b128 v[52:55], v105 offset:0
    ds_read_b128 v[56:59], v106 offset:0
    ds_read_b128 v[60:63], v107 offset:0
    ds_read_b128 v[64:67], v104 offset:256
    ds_read_b128 v[68:71], v105 offset:256
    ds_read_b128 v[72:75], v106 offset:256
    ds_read_b128 v[76:79], v107 offset:256
    v_mov_b32 v5, 11
    s_waitcnt lgkmcnt(7)
    v_mfma_f32_16x16x32_bf16 v[96:99], v[48:51], a[0:3], 0
    s_waitcnt lgkmcnt(6)
    v_mfma_f32_16x16x32_bf16 v[96:99], v[52:55], a[4:7], v[96:99]
    s_waitcnt lgkmcnt(5)
    v_mfma_f32_16x16x32_bf16 v[96:99], v[56:59], a[8:11], v[96:99]
    s_waitcnt lgkmcnt(4)
    v_mfma_f32_16x16x32_bf16 v[96:99], v[60:63], a[12:15], v[96:99]
    s_waitcnt lgkmcnt(3)
    v_mfma_f32_16x16x32_bf16 v[96:99], v[64:67], a[16:19], v[96:99]
    s_waitcnt lgkmcnt(2)
    v_mfma_f32_16x16x32_bf16 v[96:99], v[68:71], a[20:23], v[96:99]
    s_waitcnt lgkmcnt(1)
    v_mfma_f32_16x16x32_bf16 v[96:99], v[72:75], a[24:27], v[96:99]
    s_waitcnt lgkmcnt(0)
    ds_write_b32 v15, v5 offset:16
    v_mfma_f32_16x16x32_bf16 v[96:99], v[76:79], a[28:31], v[96:99]
    s_nop 7
    v_max3_f32 v110, v110, v96, v97
    v_max3_f32 v110, v110, v98, v99
    v_cvt_pk_bf16_f32 v36, v96, v97
    v_cvt_pk_bf16_f32 v37, v98, v99
    s_mov_b32 s60, s40
    s_mov_b32 s61, s41
    s_mov_b32 s62, 1605632
    s_mov_b32 s63, 0x20000
    s_lshl2_add_u32 s75, s20, s22
    s_lshl2_add_u32 s75, s75, s23
    s_mul_i32 s78, s75, 14
    v_lshrrev_b32 v10, 3, v0
    v_and_b32 v11, 7, v0
    v_mul_u32_u24 v10, 1792, v10
    v_lshl_add_u32 v111, v11, 4, v10
    s_mul_i32 s76, s78, 896
    s_add_u32 s77, s76, 896
    buffer_load_dwordx4 a[32:35], v111, s[60:63], s76 offen offset:0
    buffer_load_dwordx4 a[36:39], v111, s[60:63], s76 offen offset:128
    buffer_load_dwordx4 a[40:43], v111, s[60:63], s76 offen offset:256
    buffer_load_dwordx4 a[44:47], v111, s[60:63], s76 offen offset:384
    s_add_u32 s67, s23, 44
    s_cmp_gt_i32 s65, s67
    s_cbranch_scc1 L_wtok_66
L_wt_65:
    ds_read_b32 v4, v1 offset:0
    s_waitcnt lgkmcnt(0)
    v_readfirstlane_b32 s65, v4
    s_nop 0
    s_cmp_gt_i32 s65, s67
    s_cbranch_scc1 L_wtok_66
    s_sub_u32 s66, s66, 1
    s_cbranch_scc1 L_end
    s_branch L_wt_65
L_wtok_66:
    ds_read_b128 v[48:51], v104 offset:32768
    ds_read_b128 v[52:55], v105 offset:32768
    ds_read_b128 v[56:59], v106 offset:32768
    ds_read_b128 v[60:63], v107 offset:32768
    ds_read_b128 v[64:67], v104 offset:33024
    ds_read_b128 v[68:71], v105 offset:33024
    ds_read_b128 v[72:75], v106 offset:33024
    ds_read_b128 v[76:79], v107 offset:33024
    v_mov_b32 v5, 12
    s_waitcnt lgkmcnt(7)
    v_mfma_f32_16x16x32_bf16 v[96:99], v[48:51], a[0:3], 0
    s_waitcnt lgkmcnt(6)
    v_mfma_f32_16x16x32_bf16 v[96:99], v[52:55], a[4:7], v[96:99]
    s_waitcnt lgkmcnt(5)
    v_mfma_f32_16x16x32_bf16 v[96:99], v[56:59], a[8:11], v[96:99]
    s_waitcnt lgkmcnt(4)
    v_mfma_f32_16x16x32_bf16 v[96:99], v[60:63], a[12:15], v[96:99]
    s_waitcnt lgkmcnt(3)
    v_mfma_f32_16x16x32_bf16 v[96:99], v[64:67], a[16:19], v[96:99]
    s_waitcnt lgkmcnt(2)
    v_mfma_f32_16x16x32_bf16 v[96:99], v[68:71], a[20:23], v[96:99]
    s_waitcnt lgkmcnt(1)
    v_mfma_f32_16x16x32_bf16 v[96:99], v[72:75], a[24:27], v[96:99]
    s_waitcnt lgkmcnt(0)
    ds_write_b32 v15, v5 offset:16
    v_mfma_f32_16x16x32_bf16 v[96:99], v[76:79], a[28:31], v[96:99]
    s_nop 7
    v_max3_f32 v110, v110, v96, v97
    v_max3_f32 v110, v110, v98, v99
    v_cvt_pk_bf16_f32 v38, v96, v97
    v_cvt_pk_bf16_f32 v39, v98, v99
    buffer_load_dwordx4 a[48:51], v111, s[60:63], s76 offen offset:512
    buffer_load_dwordx4 a[52:55], v111, s[60:63], s76 offen offset:640
    buffer_load_dwordx4 a[56:59], v111, s[60:63], s76 offen offset:768
    buffer_load_dwordx4 a[60:63], v111, s[60:63], s77 offen offset:0
    s_add_u32 s67, s23, 48
    s_cmp_gt_i32 s65, s67
    s_cbranch_scc1 L_wtok_68
L_wt_67:
    ds_read_b32 v4, v1 offset:0
    s_waitcnt lgkmcnt(0)
    v_readfirstlane_b32 s65, v4
    s_nop 0
    s_cmp_gt_i32 s65, s67
    s_cbranch_scc1 L_wtok_68
    s_sub_u32 s66, s66, 1
    s_cbranch_scc1 L_end
    s_branch L_wt_67
L_wtok_68:
    ds_read_b128 v[48:51], v100 offset:0
    ds_read_b128 v[52:55], v101 offset:0
    ds_read_b128 v[56:59], v102 offset:0
    ds_read_b128 v[60:63], v103 offset:0
    ds_read_b128 v[64:67], v100 offset:256
    ds_read_b128 v[68:71], v101 offset:256
    ds_read_b128 v[72:75], v102 offset:256
    ds_read_b128 v[76:79], v103 offset:256
    v_mov_b32 v5, 13
    s_waitcnt lgkmcnt(7)
    v_mfma_f32_16x16x32_bf16 v[96:99], v[48:51], a[0:3], 0
    s_waitcnt lgkmcnt(6)
    v_mfma_f32_16x16x32_bf16 v[96:99], v[52:55], a[4:7], v[96:99]
    s_waitcnt lgkmcnt(5)
    v_mfma_f32_16x16x32_bf16 v[96:99], v[56:59], a[8:11], v[96:99]
    s_waitcnt lgkmcnt(4)
    v_mfma_f32_16x16x32_bf16 v[96:99], v[60:63], a[12:15], v[96:99]
    s_waitcnt lgkmcnt(3)
    v_mfma_f32_16x16x32_bf16 v[96:99], v[64:67], a[16:19], v[96:99]
    s_waitcnt lgkmcnt(2)
    v_mfma_f32_16x16x32_bf16 v[96:99], v[68:71], a[20:23], v[96:99]
    s_waitcnt lgkmcnt(1)
    v_mfma_f32_16x16x32_bf16 v[96:99], v[72:75], a[24:27], v[96:99]
    s_waitcnt lgkmcnt(0)
    ds_write_b32 v15, v5 offset:16
    v_mfma_f32_16x16x32_bf16 v[96:99], v[76:79], a[28:31], v[96:99]
    s_nop 7
    v_max3_f32 v110, v110, v96, v97
    v_max3_f32 v110, v110, v98, v99
    v_cvt_pk_bf16_f32 v40, v96, v97
    v_cvt_pk_bf16_f32 v41, v98, v99
    buffer_load_dwordx4 a[64:67], v111, s[60:63], s77 offen offset:128
    buffer_load_dwordx4 a[68:71], v111, s[60:63], s77 offen offset:256
    buffer_load_dwordx4 a[72:75], v111, s[60:63], s77 offen offset:384
    buffer_load_dwordx4 a[76:79], v111, s[60:63], s77 offen offset:512
    s_add_u32 s67, s23, 52
    s_cmp_gt_i32 s65, s67
    s_cbranch_scc1 L_wtok_70
L_wt_69:
    ds_read_b32 v4, v1 offset:0
    s_waitcnt lgkmcnt(0)
    v_readfirstlane_b32 s65, v4
    s_nop 0
    s_cmp_gt_i32 s65, s67
    s_cbranch_scc1 L_wtok_70
    s_sub_u32 s66, s66, 1
    s_cbranch_scc1 L_end
    s_branch L_wt_69
L_wtok_70:
    ds_read_b128 v[48:51], v100 offset:32768
    ds_read_b128 v[52:55], v101 offset:32768
    ds_read_b128 v[56:59], v102 offset:32768
    ds_read_b128 v[60:63], v103 offset:32768
    ds_read_b128 v[64:67], v100 offset:33024
    ds_read_b128 v[68:71], v101 offset:33024
    ds_read_b128 v[72:75], v102 offset:33024
    ds_read_b128 v[76:79], v103 offset:33024
    v_mov_b32 v5, 14
    s_waitcnt lgkmcnt(7)
    v_mfma_f32_16x16x32_bf16 v[96:99], v[48:51], a[0:3], 0
    s_waitcnt lgkmcnt(6)
    v_mfma_f32_16x16x32_bf16 v[96:99], v[52:55], a[4:7], v[96:99]
    s_waitcnt lgkmcnt(5)
    v_mfma_f32_16x16x32_bf16 v[96:99], v[56:59], a[8:11], v[96:99]
    s_waitcnt lgkmcnt(4)
    v_mfma_f32_16x16x32_bf16 v[96:99], v[60:63], a[12:15], v[96:99]
    s_waitcnt lgkmcnt(3)
    v_mfma_f32_16x16x32_bf16 v[96:99], v[64:67], a[16:19], v[96:99]
    s_waitcnt lgkmcnt(2)
    v_mfma_f32_16x16x32_bf16 v[96:99], v[68:71], a[20:23], v[96:99]
    s_waitcnt lgkmcnt(1)
    v_mfma_f32_16x16x32_bf16 v[96:99], v[72:75], a[24:27], v[96:99]
    s_waitcnt lgkmcnt(0)
    ds_write_b32 v15, v5 offset:16
    v_mfma_f32_16x16x32_bf16 v[96:99], v[76:79], a[28:31], v[96:99]
    s_nop 7
    v_max3_f32 v110, v110, v96, v97
    v_max3_f32 v110, v110, v98, v99
    v_cvt_pk_bf16_f32 v42, v96, v97
    v_cvt_pk_bf16_f32 v43, v98, v99
    buffer_load_dwordx4 a[80:83], v111, s[60:63], s77 offen offset:640
    buffer_load_dwordx4 a[84:87], v111, s[60:63], s77 offen offset:768
    s_add_u32 s67, s23, 56
    s_cmp_gt_i32 s65, s67
    s_cbranch_scc1 L_wtok_72
L_wt_71:
    ds_read_b32 v4, v1 offset:0
    s_waitcnt lgkmcnt(0)
    v_readfirstlane_b32 s65, v4
    s_nop 0
    s_cmp_gt_i32 s65, s67
    s_cbranch_scc1 L_wtok_72
    s_sub_u32 s66, s66, 1
    s_cbranch_scc1 L_end
    s_branch L_wt_71
L_wtok_72:
    ds_read_b128 v[48:51], v104 offset:0
    ds_read_b128 v[52:55], v105 offset:0
    ds_read_b128 v[56:59], v106 offset:0
    ds_read_b128 v[60:63], v107 offset:0
    ds_read_b128 v[64:67], v104 offset:256
    ds_read_b128 v[68:71], v105 offset:256
    ds_read_b128 v[72:75], v106 offset:256
    ds_read_b128 v[76:79], v107 offset:256
    v_mov_b32 v5, 15
    s_waitcnt lgkmcnt(7)
    v_mfma_f32_16x16x32_bf16 v[96:99], v[48:51], a[0:3], 0
    s_waitcnt lgkmcnt(6)
    v_mfma_f32_16x16x32_bf16 v[96:99], v[52:55], a[4:7], v[96:99]
    s_waitcnt lgkmcnt(5)
    v_mfma_f32_16x16x32_bf16 v[96:99], v[56:59], a[8:11], v[96:99]
    s_waitcnt lgkmcnt(4)
    v_mfma_f32_16x16x32_bf16 v[96:99], v[60:63], a[12:15], v[96:99]
    s_waitcnt lgkmcnt(3)
    v_mfma_f32_16x16x32_bf16 v[96:99], v[64:67], a[16:19], v[96:99]
    s_waitcnt lgkmcnt(2)
    v_mfma_f32_16x16x32_bf16 v[96:99], v[68:71], a[20:23], v[96:99]
    s_waitcnt lgkmcnt(1)
    v_mfma_f32_16x16x32_bf16 v[96:99], v[72:75], a[24:27], v[96:99]
    s_waitcnt lgkmcnt(0)
    ds_write_b32 v15, v5 offset:16
    v_mfma_f32_16x16x32_bf16 v[96:99], v[76:79], a[28:31], v[96:99]
    s_nop 7
    v_max3_f32 v110, v110, v96, v97
    v_max3_f32 v110, v110, v98, v99
    v_cvt_pk_bf16_f32 v44, v96, v97
    v_cvt_pk_bf16_f32 v45, v98, v99
    s_lshl_b32 s67, s21, 13
    s_lshl_b32 s75, s78, 2
    s_add_u32 s67, s67, s75
    s_add_u32 s67, s67, 135168
    v_lshrrev_b32 v10, 3, v0
    v_cmp_gt_u32 s[68:69], 7, v10
    v_min_u32 v10, 6, v10
    v_lshlrev_b32 v10, 3, v10
L_hp_73:
    buffer_load_dwordx2 v[4:5], v10, s[52:55], s67 offen sc1
    s_sub_u32 s66, s66, 1
    s_cbranch_scc1 L_end
    s_waitcnt vmcnt(0)
    v_cmp_ne_u32 vcc, s64, v5
    s_cbranch_vccnz L_hp_73
    v_cndmask_b32 v4, 0, v4, s[68:69]
    v_perm_b32 v88, v4, v4, v80
    v_perm_b32 v89, v4, v4, v81
    v_perm_b32 v90, v4, v4, v82
    v_perm_b32 v91, v4, v4, v83
    v_perm_b32 v92, v4, v4, v84
    v_perm_b32 v93, v4, v4, v85
    v_perm_b32 v94, v4, v4, v86
    v_perm_b32 v95, v4, v4, v87
    v_mfma_f32_16x16x32_bf16 a[112:115], v[88:91], a[32:35], 0
    v_mfma_f32_16x16x32_bf16 a[116:119], v[88:91], a[36:39], 0
    v_mfma_f32_16x16x32_bf16 a[120:123], v[88:91], a[40:43], 0
    v_mfma_f32_16x16x32_bf16 a[124:127], v[88:91], a[44:47], 0
    v_mfma_f32_16x16x32_bf16 a[128:131], v[88:91], a[48:51], 0
    v_mfma_f32_16x16x32_bf16 a[132:135], v[88:91], a[52:55], 0
    v_mfma_f32_16x16x32_bf16 a[136:139], v[88:91], a[56:59], 0
    v_mfma_f32_16x16x32_bf16 a[112:115], v[92:95], a[60:63], a[112:115]
    v_mfma_f32_16x16x32_bf16 a[116:119], v[92:95], a[64:67], a[116:119]
    v_mfma_f32_16x16x32_bf16 a[120:123], v[92:95], a[68:71], a[120:123]
    v_mfma_f32_16x16x32_bf16 a[124:127], v[92:95], a[72:75], a[124:127]
    v_mfma_f32_16x16x32_bf16 a[128:131], v[92:95], a[76:79], a[128:131]
    v_mfma_f32_16x16x32_bf16 a[132:135], v[92:95], a[80:83], a[132:135]
    v_mfma_f32_16x16x32_bf16 a[136:139], v[92:95], a[84:87], a[136:139]
    s_add_u32 s67, s23, 60
    s_cmp_gt_i32 s65, s67
    s_cbranch_scc1 L_wtok_75
L_wt_74:
    ds_read_b32 v4, v1 offset:0
    s_waitcnt lgkmcnt(0)
    v_readfirstlane_b32 s65, v4
    s_nop 0
    s_cmp_gt_i32 s65, s67
    s_cbranch_scc1 L_wtok_75
    s_sub_u32 s66, s66, 1
    s_cbranch_scc1 L_end
    s_branch L_wt_74
L_wtok_75:
    ds_read_b128 v[48:51], v104 offset:32768
    ds_read_b128 v[52:55], v105 offset:32768
    ds_read_b128 v[56:59], v106 offset:32768
    ds_read_b128 v[60:63], v107 offset:32768
    ds_read_b128 v[64:67], v104 offset:33024
    ds_read_b128 v[68:71], v105 offset:33024
    ds_read_b128 v[72:75], v106 offset:33024
    ds_read_b128 v[76:79], v107 offset:33024
    v_mov_b32 v5, 16
    s_waitcnt lgkmcnt(7)
    v_mfma_f32_16x16x32_bf16 v[96:99], v[48:51], a[0:3], 0
    s_waitcnt lgkmcnt(6)
    v_mfma_f32_16x16x32_bf16 v[96:99], v[52:55], a[4:7], v[96:99]
    s_waitcnt lgkmcnt(5)
    v_mfma_f32_16x16x32_bf16 v[96:99], v[56:59], a[8:11], v[96:99]
    s_waitcnt lgkmcnt(4)
    v_mfma_f32_16x16x32_bf16 v[96:99], v[60:63], a[12:15], v[96:99]
    s_waitcnt lgkmcnt(3)
    v_mfma_f32_16x16x32_bf16 v[96:99], v[64:67], a[16:19], v[96:99]
    s_waitcnt lgkmcnt(2)
    v_mfma_f32_16x16x32_bf16 v[96:99], v[68:71], a[20:23], v[96:99]
    s_waitcnt lgkmcnt(1)
    v_mfma_f32_16x16x32_bf16 v[96:99], v[72:75], a[24:27], v[96:99]
    s_waitcnt lgkmcnt(0)
    ds_write_b32 v15, v5 offset:16
    v_mfma_f32_16x16x32_bf16 v[96:99], v[76:79], a[28:31], v[96:99]
    s_nop 7
    v_max3_f32 v110, v110, v96, v97
    v_max3_f32 v110, v110, v98, v99
    v_cvt_pk_bf16_f32 v46, v96, v97
    v_cvt_pk_bf16_f32 v47, v98, v99
    v_lshrrev_b32 v10, 3, v0
    v_lshlrev_b32 v10, 3, v10
    s_lshl_b32 s67, s23, 6
    s_add_u32 s67, s67, 133120
    v_add_u32 v10, s67, v10
    ds_write_b64 v10, v[42:43] offset:0
    ds_write_b64 v10, v[44:45] offset:256
    ds_write_b64 v10, v[46:47] offset:512
    v_mov_b32 v4, v110
    s_nop 1
    v_permlane16_swap_b32 v110, v4
    v_max_f32 v110, v110, v4
    v_mov_b32 v4, v110
    s_nop 1
    v_permlane32_swap_b32 v110, v4
    v_max_f32 v110, v110, v4
    v_cvt_pk_bf16_f32 v110, v110, v110
    v_lshlrev_b32 v110, 16, v110
    v_bfe_u32 v10, v0, 3, 1
    v_lshl_add_u32 v10, v10, 2, v1
    s_lshl_b32 s67, s23, 3
    v_add_u32 v11, s67, v10
    ds_write_b32 v11, v110 offset:128
    ds_write_b32 v15, v14 offset:80
L_wf_76:
    ds_read_b128 v[4:7], v1 offset:80
    s_waitcnt lgkmcnt(0)
    v_min3_u32 v4, v4, v5, v6
    v_min_u32 v4, v4, v7
    s_nop 0
    v_readfirstlane_b32 s67, v4
    s_nop 0
    s_cmp_lg_u32 s67, 0
    s_cbranch_scc1 L_wfok_77
    s_sub_u32 s66, s66, 1
    s_cbranch_scc1 L_end
    s_branch L_wf_76
L_wfok_77:
    ds_read2_b32 v[4:5], v10 offset0:32 offset1:34
    ds_read2_b32 v[6:7], v10 offset0:36 offset1:38
    s_mov_b32 s75, 0x3db8aa3b
    v_mov_b32 v111, 0
    v_mov_b32 v12, 0
    s_waitcnt lgkmcnt(0)
    v_max3_f32 v4, v4, v5, v6
    v_max_f32 v110, v4, v7
    v_mul_f32 v13, 0xbdb8aa3b, v110
    v_lshlrev_b32 v4, 16, v16
    v_and_b32 v5, 0xffff0000, v16
    v_lshlrev_b32 v6, 16, v17
    v_and_b32 v7, 0xffff0000, v17
    v_fma_f32 v4, v4, s75, v13
    v_fma_f32 v5, v5, s75, v13
    v_fma_f32 v6, v6, s75, v13
    v_fma_f32 v7, v7, s75, v13
    v_exp_f32 v4, v4
    v_exp_f32 v5, v5
    v_exp_f32 v6, v6
    v_exp_f32 v7, v7
    v_add_f32 v111, v111, v4
    v_add_f32 v12, v12, v5
    v_cvt_pk_bf16_f32 v16, v4, v5
    v_add_f32 v111, v111, v6
    v_add_f32 v12, v12, v7
    v_cvt_pk_bf16_f32 v17, v6, v7
    v_lshlrev_b32 v4, 16, v18
    v_and_b32 v5, 0xffff0000, v18
    v_lshlrev_b32 v6, 16, v19
    v_and_b32 v7, 0xffff0000, v19
    v_fma_f32 v4, v4, s75, v13
    v_fma_f32 v5, v5, s75, v13
    v_fma_f32 v6, v6, s75, v13
    v_fma_f32 v7, v7, s75, v13
    v_exp_f32 v4, v4
    v_exp_f32 v5, v5
    v_exp_f32 v6, v6
    v_exp_f32 v7, v7
    v_add_f32 v111, v111, v4
    v_add_f32 v12, v12, v5
    v_cvt_pk_bf16_f32 v18, v4, v5
    v_add_f32 v111, v111, v6
    v_add_f32 v12, v12, v7
    v_cvt_pk_bf16_f32 v19, v6, v7
    v_lshlrev_b32 v4, 16, v20
    v_and_b32 v5, 0xffff0000, v20
    v_lshlrev_b32 v6, 16, v21
    v_and_b32 v7, 0xffff0000, v21
    v_fma_f32 v4, v4, s75, v13
    v_fma_f32 v5, v5, s75, v13
    v_fma_f32 v6, v6, s75, v13
    v_fma_f32 v7, v7, s75, v13
    v_exp_f32 v4, v4
    v_exp_f32 v5, v5
    v_exp_f32 v6, v6
    v_exp_f32 v7, v7
    v_add_f32 v111, v111, v4
    v_add_f32 v12, v12, v5
    v_cvt_pk_bf16_f32 v20, v4, v5
    v_add_f32 v111, v111, v6
    v_add_f32 v12, v12, v7
    v_cvt_pk_bf16_f32 v21, v6, v7
    v_lshlrev_b32 v4, 16, v22
    v_and_b32 v5, 0xffff0000, v22
    v_lshlrev_b32 v6, 16, v23
    v_and_b32 v7, 0xffff0000, v23
    v_fma_f32 v4, v4, s75, v13
    v_fma_f32 v5, v5, s75, v13
    v_fma_f32 v6, v6, s75, v13
    v_fma_f32 v7, v7, s75, v13
    v_exp_f32 v4, v4
    v_exp_f32 v5, v5
    v_exp_f32 v6, v6
    v_exp_f32 v7, v7
    v_add_f32 v111, v111, v4
    v_add_f32 v12, v12, v5
    v_cvt_pk_bf16_f32 v22, v4, v5
    v_add_f32 v111, v111, v6
    v_add_f32 v12, v12, v7
    v_cvt_pk_bf16_f32 v23, v6, v7
    v_lshlrev_b32 v4, 16, v24
    v_and_b32 v5, 0xffff0000, v24
    v_lshlrev_b32 v6, 16, v25
    v_and_b32 v7, 0xffff0000, v25
    v_fma_f32 v4, v4, s75, v13
    v_fma_f32 v5, v5, s75, v13
    v_fma_f32 v6, v6, s75, v13
    v_fma_f32 v7, v7, s75, v13
    v_exp_f32 v4, v4
    v_exp_f32 v5, v5
    v_exp_f32 v6, v6
    v_exp_f32 v7, v7
    v_add_f32 v111, v111, v4
    v_add_f32 v12, v12, v5
    v_cvt_pk_bf16_f32 v24, v4, v5
    v_add_f32 v111, v111, v6
    v_add_f32 v12, v12, v7
    v_cvt_pk_bf16_f32 v25, v6, v7
    v_lshlrev_b32 v4, 16, v26
    v_and_b32 v5, 0xffff0000, v26
    v_lshlrev_b32 v6, 16, v27
    v_and_b32 v7, 0xffff0000, v27
    v_fma_f32 v4, v4, s75, v13
    v_fma_f32 v5, v5, s75, v13
    v_fma_f32 v6, v6, s75, v13
    v_fma_f32 v7, v7, s75, v13
    v_exp_f32 v4, v4
    v_exp_f32 v5, v5
    v_exp_f32 v6, v6
    v_exp_f32 v7, v7
    v_add_f32 v111, v111, v4
    v_add_f32 v12, v12, v5
    v_cvt_pk_bf16_f32 v26, v4, v5
    v_add_f32 v111, v111, v6
    v_add_f32 v12, v12, v7
    v_cvt_pk_bf16_f32 v27, v6, v7
    v_lshlrev_b32 v4, 16, v28
    v_and_b32 v5, 0xffff0000, v28
    v_lshlrev_b32 v6, 16, v29
    v_and_b32 v7, 0xffff0000, v29
    v_fma_f32 v4, v4, s75, v13
    v_fma_f32 v5, v5, s75, v13
    v_fma_f32 v6, v6, s75, v13
    v_fma_f32 v7, v7, s75, v13
    v_exp_f32 v4, v4
    v_exp_f32 v5, v5
    v_exp_f32 v6, v6
    v_exp_f32 v7, v7
    v_add_f32 v111, v111, v4
    v_add_f32 v12, v12, v5
    v_cvt_pk_bf16_f32 v28, v4, v5
    v_add_f32 v111, v111, v6
    v_add_f32 v12, v12, v7
    v_cvt_pk_bf16_f32 v29, v6, v7
    v_lshlrev_b32 v4, 16, v30
    v_and_b32 v5, 0xffff0000, v30
    v_lshlrev_b32 v6, 16, v31
    v_and_b32 v7, 0xffff0000, v31
    v_fma_f32 v4, v4, s75, v13
    v_fma_f32 v5, v5, s75, v13
    v_fma_f32 v6, v6, s75, v13
    v_fma_f32 v7, v7, s75, v13
    v_exp_f32 v4, v4
    v_exp_f32 v5, v5
    v_exp_f32 v6, v6
    v_exp_f32 v7, v7
    v_add_f32 v111, v111, v4
    v_add_f32 v12, v12, v5
    v_cvt_pk_bf16_f32 v30, v4, v5
    v_add_f32 v111, v111, v6
    v_add_f32 v12, v12, v7
    v_cvt_pk_bf16_f32 v31, v6, v7
    v_lshlrev_b32 v4, 16, v32
    v_and_b32 v5, 0xffff0000, v32
    v_lshlrev_b32 v6, 16, v33
    v_and_b32 v7, 0xffff0000, v33
    v_fma_f32 v4, v4, s75, v13
    v_fma_f32 v5, v5, s75, v13
    v_fma_f32 v6, v6, s75, v13
    v_fma_f32 v7, v7, s75, v13
    v_exp_f32 v4, v4
    v_exp_f32 v5, v5
    v_exp_f32 v6, v6
    v_exp_f32 v7, v7
    v_add_f32 v111, v111, v4
    v_add_f32 v12, v12, v5
    v_cvt_pk_bf16_f32 v32, v4, v5
    v_add_f32 v111, v111, v6
    v_add_f32 v12, v12, v7
    v_cvt_pk_bf16_f32 v33, v6, v7
    v_lshlrev_b32 v4, 16, v34
    v_and_b32 v5, 0xffff0000, v34
    v_lshlrev_b32 v6, 16, v35
    v_and_b32 v7, 0xffff0000, v35
    v_fma_f32 v4, v4, s75, v13
    v_fma_f32 v5, v5, s75, v13
    v_fma_f32 v6, v6, s75, v13
    v_fma_f32 v7, v7, s75, v13
    v_exp_f32 v4, v4
    v_exp_f32 v5, v5
    v_exp_f32 v6, v6
    v_exp_f32 v7, v7
    v_add_f32 v111, v111, v4
    v_add_f32 v12, v12, v5
    v_cvt_pk_bf16_f32 v34, v4, v5
    v_add_f32 v111, v111, v6
    v_add_f32 v12, v12, v7
    v_cvt_pk_bf16_f32 v35, v6, v7
    v_lshlrev_b32 v4, 16, v36
    v_and_b32 v5, 0xffff0000, v36
    v_lshlrev_b32 v6, 16, v37
    v_and_b32 v7, 0xffff0000, v37
    v_fma_f32 v4, v4, s75, v13
    v_fma_f32 v5, v5, s75, v13
    v_fma_f32 v6, v6, s75, v13
    v_fma_f32 v7, v7, s75, v13
    v_exp_f32 v4, v4
    v_exp_f32 v5, v5
    v_exp_f32 v6, v6
    v_exp_f32 v7, v7
    v_add_f32 v111, v111, v4
    v_add_f32 v12, v12, v5
    v_cvt_pk_bf16_f32 v36, v4, v5
    v_add_f32 v111, v111, v6
    v_add_f32 v12, v12, v7
    v_cvt_pk_bf16_f32 v37, v6, v7
    v_lshlrev_b32 v4, 16, v38
    v_and_b32 v5, 0xffff0000, v38
    v_lshlrev_b32 v6, 16, v39
    v_and_b32 v7, 0xffff0000, v39
    v_fma_f32 v4, v4, s75, v13
    v_fma_f32 v5, v5, s75, v13
    v_fma_f32 v6, v6, s75, v13
    v_fma_f32 v7, v7, s75, v13
    v_exp_f32 v4, v4
    v_exp_f32 v5, v5
    v_exp_f32 v6, v6
    v_exp_f32 v7, v7
    v_add_f32 v111, v111, v4
    v_add_f32 v12, v12, v5
    v_cvt_pk_bf16_f32 v38, v4, v5
    v_add_f32 v111, v111, v6
    v_add_f32 v12, v12, v7
    v_cvt_pk_bf16_f32 v39, v6, v7
    v_lshlrev_b32 v4, 16, v40
    v_and_b32 v5, 0xffff0000, v40
    v_lshlrev_b32 v6, 16, v41
    v_and_b32 v7, 0xffff0000, v41
    v_fma_f32 v4, v4, s75, v13
    v_fma_f32 v5, v5, s75, v13
    v_fma_f32 v6, v6, s75, v13
    v_fma_f32 v7, v7, s75, v13
    v_exp_f32 v4, v4
    v_exp_f32 v5, v5
    v_exp_f32 v6, v6
    v_exp_f32 v7, v7
    v_add_f32 v111, v111, v4
    v_add_f32 v12, v12, v5
    v_cvt_pk_bf16_f32 v40, v4, v5
    v_add_f32 v111, v111, v6
    v_add_f32 v12, v12, v7
    v_cvt_pk_bf16_f32 v41, v6, v7
    v_lshlrev_b32 v4, 16, v42
    v_and_b32 v5, 0xffff0000, v42
    v_lshlrev_b32 v6, 16, v43
    v_and_b32 v7, 0xffff0000, v43
    v_fma_f32 v4, v4, s75, v13
    v_fma_f32 v5, v5, s75, v13
    v_fma_f32 v6, v6, s75, v13
    v_fma_f32 v7, v7, s75, v13
    v_exp_f32 v4, v4
    v_exp_f32 v5, v5
    v_exp_f32 v6, v6
    v_exp_f32 v7, v7
    v_add_f32 v111, v111, v4
    v_add_f32 v12, v12, v5
    v_cvt_pk_bf16_f32 v42, v4, v5
    v_add_f32 v111, v111, v6
    v_add_f32 v12, v12, v7
    v_cvt_pk_bf16_f32 v43, v6, v7
    v_lshlrev_b32 v4, 16, v44
    v_and_b32 v5, 0xffff0000, v44
    v_lshlrev_b32 v6, 16, v45
    v_and_b32 v7, 0xffff0000, v45
    v_fma_f32 v4, v4, s75, v13
    v_fma_f32 v5, v5, s75, v13
    v_fma_f32 v6, v6, s75, v13
    v_fma_f32 v7, v7, s75, v13
    v_exp_f32 v4, v4
    v_exp_f32 v5, v5
    v_exp_f32 v6, v6
    v_exp_f32 v7, v7
    v_add_f32 v111, v111, v4
    v_add_f32 v12, v12, v5
    v_cvt_pk_bf16_f32 v44, v4, v5
    v_add_f32 v111, v111, v6
    v_add_f32 v12, v12, v7
    v_cvt_pk_bf16_f32 v45, v6, v7
    v_lshlrev_b32 v4, 16, v46
    v_and_b32 v5, 0xffff0000, v46
    v_lshlrev_b32 v6, 16, v47
    v_and_b32 v7, 0xffff0000, v47
    v_fma_f32 v4, v4, s75, v13
    v_fma_f32 v5, v5, s75, v13
    v_fma_f32 v6, v6, s75, v13
    v_fma_f32 v7, v7, s75, v13
    v_exp_f32 v4, v4
    v_exp_f32 v5, v5
    v_exp_f32 v6, v6
    v_exp_f32 v7, v7
    v_add_f32 v111, v111, v4
    v_add_f32 v12, v12, v5
    v_cvt_pk_bf16_f32 v46, v4, v5
    v_add_f32 v111, v111, v6
    v_add_f32 v12, v12, v7
    v_cvt_pk_bf16_f32 v47, v6, v7
    v_add_f32 v111, v111, v12
    v_mov_b32 v4, v111
    s_nop 1
    v_permlane16_swap_b32 v111, v4
    v_add_f32 v111, v111, v4
    v_mov_b32 v4, v111
    s_nop 1
    v_permlane32_swap_b32 v111, v4
    v_add_f32 v111, v111, v4
    ds_write_b32 v11, v111 offset:160
    ds_write_b32 v15, v14 offset:96
    s_mov_b32 s60, s30
    s_mov_b32 s61, s31
    s_mov_b32 s62, 3670016
    s_mov_b32 s63, 0x20000
    s_lshl_b32 s75, s20, 5
    s_lshl2_add_u32 s78, s101, s23
    s_add_u32 s75, s75, s78
    s_mul_i32 s78, s75, 16*896
    v_lshrrev_b32 v10, 5, v0
    v_bfe_u32 v11, v0, 4, 1
    v_lshl_add_u32 v10, v10, 2, v11
    v_bfe_u32 v11, v0, 3, 1
    v_lshl_add_u32 v10, v11, 8, v10
    v_and_b32 v11, 7, v0
    v_mul_u32_u24 v10, 896, v10
    v_lshl_add_u32 v111, v11, 4, v10
    s_add_u32 s67, s23, 64
    s_cmp_gt_i32 s65, s67
    s_cbranch_scc1 L_wtok_79
L_wt_78:
    ds_read_b32 v4, v1 offset:0
    s_waitcnt lgkmcnt(0)
    v_readfirstlane_b32 s65, v4
    s_nop 0
    s_cmp_gt_i32 s65, s67
    s_cbranch_scc1 L_wtok_79
    s_sub_u32 s66, s66, 1
    s_cbranch_scc1 L_end
    s_branch L_wt_78
L_wtok_79:
    ds_read_b128 v[48:51], v108 offset:0
    ds_read_b128 v[52:55], v108 offset:256
    ds_read_b128 v[56:59], v108 offset:512
    ds_read_b128 v[60:63], v108 offset:768
    ds_read_b128 v[64:67], v108 offset:1024
    ds_read_b128 v[68:71], v108 offset:1280
    ds_read_b128 v[72:75], v108 offset:1536
    ds_read_b128 v[76:79], v108 offset:1792
    v_mov_b32 v5, 17
    v_perm_b32 v88, v16, v16, v80
    v_perm_b32 v89, v16, v16, v81
    v_perm_b32 v90, v16, v16, v82
    v_perm_b32 v91, v16, v16, v83
    s_waitcnt lgkmcnt(7)
    s_nop 0
    v_mfma_f32_16x16x32_bf16 v[100:103], v[88:91], v[48:51], 0
    s_waitcnt lgkmcnt(6)
    v_mfma_f32_16x16x32_bf16 v[104:107], v[88:91], v[52:55], 0
    v_perm_b32 v92, v16, v16, v84
    v_perm_b32 v93, v16, v16, v85
    v_perm_b32 v94, v16, v16, v86
    v_perm_b32 v95, v16, v16, v87
    s_waitcnt lgkmcnt(5)
    s_nop 0
    v_mfma_f32_16x16x32_bf16 v[100:103], v[92:95], v[56:59], v[100:103]
    s_waitcnt lgkmcnt(4)
    v_mfma_f32_16x16x32_bf16 v[104:107], v[92:95], v[60:63], v[104:107]
    v_perm_b32 v88, v17, v17, v80
    v_perm_b32 v89, v17, v17, v81
    v_perm_b32 v90, v17, v17, v82
    v_perm_b32 v91, v17, v17, v83
    s_waitcnt lgkmcnt(3)
    s_nop 0
    v_mfma_f32_16x16x32_bf16 v[100:103], v[88:91], v[64:67], v[100:103]
    s_waitcnt lgkmcnt(2)
    v_mfma_f32_16x16x32_bf16 v[104:107], v[88:91], v[68:71], v[104:107]
    v_perm_b32 v92, v17, v17, v84
    v_perm_b32 v93, v17, v17, v85
    v_perm_b32 v94, v17, v17, v86
    v_perm_b32 v95, v17, v17, v87
    s_waitcnt lgkmcnt(1)
    s_nop 0
    v_mfma_f32_16x16x32_bf16 v[100:103], v[92:95], v[72:75], v[100:103]
    s_waitcnt lgkmcnt(0)
    ds_write_b32 v15, v5 offset:16
    v_mfma_f32_16x16x32_bf16 v[104:107], v[92:95], v[76:79], v[104:107]
    s_add_u32 s67, s78, 0
    buffer_load_dwordx4 a[0:3], v111, s[60:63], s67 offen offset:0
    buffer_load_dwordx4 a[8:11], v111, s[60:63], s67 offen offset:128
    buffer_load_dwordx4 a[16:19], v111, s[60:63], s67 offen offset:256
    buffer_load_dwordx4 a[24:27], v111, s[60:63], s67 offen offset:384
L_wob_80:
    s_add_u32 s67, s23, 68
    s_cmp_gt_i32 s65, s67
    s_cbranch_scc1 L_wtok_82
L_wt_81:
    ds_read_b32 v4, v1 offset:0
    s_waitcnt lgkmcnt(0)
    v_readfirstlane_b32 s65, v4
    s_nop 0
    s_cmp_gt_i32 s65, s67
    s_cbranch_scc1 L_wtok_82
    s_sub_u32 s66, s66, 1
    s_cbranch_scc1 L_end
    s_branch L_wt_81
L_wtok_82:
    ds_read_b128 v[48:51], v108 offset:32768
    ds_read_b128 v[52:55], v108 offset:33024
    ds_read_b128 v[56:59], v108 offset:33280
    ds_read_b128 v[60:63], v108 offset:33536
    ds_read_b128 v[64:67], v108 offset:33792
    ds_read_b128 v[68:71], v108 offset:34048
    ds_read_b128 v[72:75], v108 offset:34304
    ds_read_b128 v[76:79], v108 offset:34560
    v_mov_b32 v5, 18
    v_perm_b32 v88, v18, v18, v80
    v_perm_b32 v89, v18, v18, v81
    v_perm_b32 v90, v18, v18, v82
    v_perm_b32 v91, v18, v18, v83
    s_waitcnt lgkmcnt(7)
    s_nop 0
    v_mfma_f32_16x16x32_bf16 v[100:103], v[88:91], v[48:51], v[100:103]
    s_waitcnt lgkmcnt(6)
    v_mfma_f32_16x16x32_bf16 v[104:107], v[88:91], v[52:55], v[104:107]
    v_perm_b32 v92, v18, v18, v84
    v_perm_b32 v93, v18, v18, v85
    v_perm_b32 v94, v18, v18, v86
    v_perm_b32 v95, v18, v18, v87
    s_waitcnt lgkmcnt(5)
    s_nop 0
    v_mfma_f32_16x16x32_bf16 v[100:103], v[92:95], v[56:59], v[100:103]
    s_waitcnt lgkmcnt(4)
    v_mfma_f32_16x16x32_bf16 v[104:107], v[92:95], v[60:63], v[104:107]
    v_perm_b32 v88, v19, v19, v80
    v_perm_b32 v89, v19, v19, v81
    v_perm_b32 v90, v19, v19, v82
    v_perm_b32 v91, v19, v19, v83
    s_waitcnt lgkmcnt(3)
    s_nop 0
    v_mfma_f32_16x16x32_bf16 v[100:103], v[88:91], v[64:67], v[100:103]
    s_waitcnt lgkmcnt(2)
    v_mfma_f32_16x16x32_bf16 v[104:107], v[88:91], v[68:71], v[104:107]
    v_perm_b32 v92, v19, v19, v84
    v_perm_b32 v93, v19, v19, v85
    v_perm_b32 v94, v19, v19, v86
    v_perm_b32 v95, v19, v19, v87
    s_waitcnt lgkmcnt(1)
    s_nop 0
    v_mfma_f32_16x16x32_bf16 v[100:103], v[92:95], v[72:75], v[100:103]
    s_waitcnt lgkmcnt(0)
    ds_write_b32 v15, v5 offset:16
    v_mfma_f32_16x16x32_bf16 v[104:107], v[92:95], v[76:79], v[104:107]
    s_add_u32 s67, s78, 0
    buffer_load_dwordx4 a[32:35], v111, s[60:63], s67 offen offset:512
    buffer_load_dwordx4 a[40:43], v111, s[60:63], s67 offen offset:640
    buffer_load_dwordx4 a[48:51], v111, s[60:63], s67 offen offset:768
    s_add_u32 s67, s78, 7168
    buffer_load_dwordx4 a[4:7], v111, s[60:63], s67 offen offset:0
L_wob_83:
    s_add_u32 s67, s23, 72
    s_cmp_gt_i32 s65, s67
    s_cbranch_scc1 L_wtok_85
L_wt_84:
    ds_read_b32 v4, v1 offset:0
    s_waitcnt lgkmcnt(0)
    v_readfirstlane_b32 s65, v4
    s_nop 0
    s_cmp_gt_i32 s65, s67
    s_cbranch_scc1 L_wtok_85
    s_sub_u32 s66, s66, 1
    s_cbranch_scc1 L_end
    s_branch L_wt_84
L_wtok_85:
    ds_read_b128 v[48:51], v109 offset:0
    ds_read_b128 v[52:55], v109 offset:256
    ds_read_b128 v[56:59], v109 offset:512
    ds_read_b128 v[60:63], v109 offset:768
    ds_read_b128 v[64:67], v109 offset:1024
    ds_read_b128 v[68:71], v109 offset:1280
    ds_read_b128 v[72:75], v109 offset:1536
    ds_read_b128 v[76:79], v109 offset:1792
    v_mov_b32 v5, 19
    v_perm_b32 v88, v20, v20, v80
    v_perm_b32 v89, v20, v20, v81
    v_perm_b32 v90, v20, v20, v82
    v_perm_b32 v91, v20, v20, v83
    s_waitcnt lgkmcnt(7)
    s_nop 0
    v_mfma_f32_16x16x32_bf16 v[100:103], v[88:91], v[48:51], v[100:103]
    s_waitcnt lgkmcnt(6)
    v_mfma_f32_16x16x32_bf16 v[104:107], v[88:91], v[52:55], v[104:107]
    v_perm_b32 v92, v20, v20, v84
    v_perm_b32 v93, v20, v20, v85
    v_perm_b32 v94, v20, v20, v86
    v_perm_b32 v95, v20, v20, v87
    s_waitcnt lgkmcnt(5)
    s_nop 0
    v_mfma_f32_16x16x32_bf16 v[100:103], v[92:95], v[56:59], v[100:103]
    s_waitcnt lgkmcnt(4)
    v_mfma_f32_16x16x32_bf16 v[104:107], v[92:95], v[60:63], v[104:107]
    v_perm_b32 v88, v21, v21, v80
    v_perm_b32 v89, v21, v21, v81
    v_perm_b32 v90, v21, v21, v82
    v_perm_b32 v91, v21, v21, v83
    s_waitcnt lgkmcnt(3)
    s_nop 0
    v_mfma_f32_16x16x32_bf16 v[100:103], v[88:91], v[64:67], v[100:103]
    s_waitcnt lgkmcnt(2)
    v_mfma_f32_16x16x32_bf16 v[104:107], v[88:91], v[68:71], v[104:107]
    v_perm_b32 v92, v21, v21, v84
    v_perm_b32 v93, v21, v21, v85
    v_perm_b32 v94, v21, v21, v86
    v_perm_b32 v95, v21, v21, v87
    s_waitcnt lgkmcnt(1)
    s_nop 0
    v_mfma_f32_16x16x32_bf16 v[100:103], v[92:95], v[72:75], v[100:103]
    s_waitcnt lgkmcnt(0)
    ds_write_b32 v15, v5 offset:16
    v_mfma_f32_16x16x32_bf16 v[104:107], v[92:95], v[76:79], v[104:107]
    s_add_u32 s67, s78, 7168
    buffer_load_dwordx4 a[12:15], v111, s[60:63], s67 offen offset:128
    buffer_load_dwordx4 a[20:23], v111, s[60:63], s67 offen offset:256
    buffer_load_dwordx4 a[28:31], v111, s[60:63], s67 offen offset:384
    buffer_load_dwordx4 a[36:39], v111, s[60:63], s67 offen offset:512
L_wob_86:
    s_add_u32 s67, s23, 76
    s_cmp_gt_i32 s65, s67
    s_cbranch_scc1 L_wtok_88
L_wt_87:
    ds_read_b32 v4, v1 offset:0
    s_waitcnt lgkmcnt(0)
    v_readfirstlane_b32 s65, v4
    s_nop 0
    s_cmp_gt_i32 s65, s67
    s_cbranch_scc1 L_wtok_88
    s_sub_u32 s66, s66, 1
    s_cbranch_scc1 L_end
    s_branch L_wt_87
L_wtok_88:
    ds_read_b128 v[48:51], v109 offset:32768
    ds_read_b128 v[52:55], v109 offset:33024
    ds_read_b128 v[56:59], v109 offset:33280
    ds_read_b128 v[60:63], v109 offset:33536
    ds_read_b128 v[64:67], v109 offset:33792
    ds_read_b128 v[68:71], v109 offset:34048
    ds_read_b128 v[72:75], v109 offset:34304
    ds_read_b128 v[76:79], v109 offset:34560
    v_mov_b32 v5, 20
    v_perm_b32 v88, v22, v22, v80
    v_perm_b32 v89, v22, v22, v81
    v_perm_b32 v90, v22, v22, v82
    v_perm_b32 v91, v22, v22, v83
    s_waitcnt lgkmcnt(7)
    s_nop 0
    v_mfma_f32_16x16x32_bf16 v[100:103], v[88:91], v[48:51], v[100:103]
    s_waitcnt lgkmcnt(6)
    v_mfma_f32_16x16x32_bf16 v[104:107], v[88:91], v[52:55], v[104:107]
    v_perm_b32 v92, v22, v22, v84
    v_perm_b32 v93, v22, v22, v85
    v_perm_b32 v94, v22, v22, v86
    v_perm_b32 v95, v22, v22, v87
    s_waitcnt lgkmcnt(5)
    s_nop 0
    v_mfma_f32_16x16x32_bf16 v[100:103], v[92:95], v[56:59], v[100:103]
    s_waitcnt lgkmcnt(4)
    v_mfma_f32_16x16x32_bf16 v[104:107], v[92:95], v[60:63], v[104:107]
    v_perm_b32 v88, v23, v23, v80
    v_perm_b32 v89, v23, v23, v81
    v_perm_b32 v90, v23, v23, v82
    v_perm_b32 v91, v23, v23, v83
    s_waitcnt lgkmcnt(3)
    s_nop 0
    v_mfma_f32_16x16x32_bf16 v[100:103], v[88:91], v[64:67], v[100:103]
    s_waitcnt lgkmcnt(2)
    v_mfma_f32_16x16x32_bf16 v[104:107], v[88:91], v[68:71], v[104:107]
    v_perm_b32 v92, v23, v23, v84
    v_perm_b32 v93, v23, v23, v85
    v_perm_b32 v94, v23, v23, v86
    v_perm_b32 v95, v23, v23, v87
    s_waitcnt lgkmcnt(1)
    s_nop 0
    v_mfma_f32_16x16x32_bf16 v[100:103], v[92:95], v[72:75], v[100:103]
    s_waitcnt lgkmcnt(0)
    ds_write_b32 v15, v5 offset:16
    v_mfma_f32_16x16x32_bf16 v[104:107], v[92:95], v[76:79], v[104:107]
    s_add_u32 s67, s78, 7168
    buffer_load_dwordx4 a[44:47], v111, s[60:63], s67 offen offset:640
    buffer_load_dwordx4 a[52:55], v111, s[60:63], s67 offen offset:768
    s_add_u32 s67, s78, 1792
    buffer_load_dwordx4 a[56:59], v111, s[60:63], s67 offen offset:0
    buffer_load_dwordx4 a[64:67], v111, s[60:63], s67 offen offset:128
L_wob_89:
    s_add_u32 s67, s23, 80
    s_cmp_gt_i32 s65, s67
    s_cbranch_scc1 L_wtok_91
L_wt_90:
    ds_read_b32 v4, v1 offset:0
    s_waitcnt lgkmcnt(0)
    v_readfirstlane_b32 s65, v4
    s_nop 0
    s_cmp_gt_i32 s65, s67
    s_cbranch_scc1 L_wtok_91
    s_sub_u32 s66, s66, 1
    s_cbranch_scc1 L_end
    s_branch L_wt_90
L_wtok_91:
    ds_read_b128 v[48:51], v108 offset:0
    ds_read_b128 v[52:55], v108 offset:256
    ds_read_b128 v[56:59], v108 offset:512
    ds_read_b128 v[60:63], v108 offset:768
    ds_read_b128 v[64:67], v108 offset:1024
    ds_read_b128 v[68:71], v108 offset:1280
    ds_read_b128 v[72:75], v108 offset:1536
    ds_read_b128 v[76:79], v108 offset:1792
    v_mov_b32 v5, 21
    v_perm_b32 v88, v24, v24, v80
    v_perm_b32 v89, v24, v24, v81
    v_perm_b32 v90, v24, v24, v82
    v_perm_b32 v91, v24, v24, v83
    s_waitcnt lgkmcnt(7)
    s_nop 0
    v_mfma_f32_16x16x32_bf16 v[100:103], v[88:91], v[48:51], v[100:103]
    s_waitcnt lgkmcnt(6)
    v_mfma_f32_16x16x32_bf16 v[104:107], v[88:91], v[52:55], v[104:107]
    v_perm_b32 v92, v24, v24, v84
    v_perm_b32 v93, v24, v24, v85
    v_perm_b32 v94, v24, v24, v86
    v_perm_b32 v95, v24, v24, v87
    s_waitcnt lgkmcnt(5)
    s_nop 0
    v_mfma_f32_16x16x32_bf16 v[100:103], v[92:95], v[56:59], v[100:103]
    s_waitcnt lgkmcnt(4)
    v_mfma_f32_16x16x32_bf16 v[104:107], v[92:95], v[60:63], v[104:107]
    v_perm_b32 v88, v25, v25, v80
    v_perm_b32 v89, v25, v25, v81
    v_perm_b32 v90, v25, v25, v82
    v_perm_b32 v91, v25, v25, v83
    s_waitcnt lgkmcnt(3)
    s_nop 0
    v_mfma_f32_16x16x32_bf16 v[100:103], v[88:91], v[64:67], v[100:103]
    s_waitcnt lgkmcnt(2)
    v_mfma_f32_16x16x32_bf16 v[104:107], v[88:91], v[68:71], v[104:107]
    v_perm_b32 v92, v25, v25, v84
    v_perm_b32 v93, v25, v25, v85
    v_perm_b32 v94, v25, v25, v86
    v_perm_b32 v95, v25, v25, v87
    s_waitcnt lgkmcnt(1)
    s_nop 0
    v_mfma_f32_16x16x32_bf16 v[100:103], v[92:95], v[72:75], v[100:103]
    s_waitcnt lgkmcnt(0)
    ds_write_b32 v15, v5 offset:16
    v_mfma_f32_16x16x32_bf16 v[104:107], v[92:95], v[76:79], v[104:107]
    s_add_u32 s67, s78, 1792
    buffer_load_dwordx4 a[72:75], v111, s[60:63], s67 offen offset:256
    buffer_load_dwordx4 a[80:83], v111, s[60:63], s67 offen offset:384
    buffer_load_dwordx4 a[88:91], v111, s[60:63], s67 offen offset:512
    buffer_load_dwordx4 a[96:99], v111, s[60:63], s67 offen offset:640
L_wob_92:
    s_add_u32 s67, s23, 84
    s_cmp_gt_i32 s65, s67
    s_cbranch_scc1 L_wtok_94
L_wt_93:
    ds_read_b32 v4, v1 offset:0
    s_waitcnt lgkmcnt(0)
    v_readfirstlane_b32 s65, v4
    s_nop 0
    s_cmp_gt_i32 s65, s67
    s_cbranch_scc1 L_wtok_94
    s_sub_u32 s66, s66, 1
    s_cbranch_scc1 L_end
    s_branch L_wt_93
L_wtok_94:
    ds_read_b128 v[48:51], v108 offset:32768
    ds_read_b128 v[52:55], v108 offset:33024
    ds_read_b128 v[56:59], v108 offset:33280
    ds_read_b128 v[60:63], v108 offset:33536
    ds_read_b128 v[64:67], v108 offset:33792
    ds_read_b128 v[68:71], v108 offset:34048
    ds_read_b128 v[72:75], v108 offset:34304
    ds_read_b128 v[76:79], v108 offset:34560
    v_mov_b32 v5, 22
    v_perm_b32 v88, v26, v26, v80
    v_perm_b32 v89, v26, v26, v81
    v_perm_b32 v90, v26, v26, v82
    v_perm_b32 v91, v26, v26, v83
    s_waitcnt lgkmcnt(7)
    s_nop 0
    v_mfma_f32_16x16x32_bf16 v[100:103], v[88:91], v[48:51], v[100:103]
    s_waitcnt lgkmcnt(6)
    v_mfma_f32_16x16x32_bf16 v[104:107], v[88:91], v[52:55], v[104:107]
    v_perm_b32 v92, v26, v26, v84
    v_perm_b32 v93, v26, v26, v85
    v_perm_b32 v94, v26, v26, v86
    v_perm_b32 v95, v26, v26, v87
    s_waitcnt lgkmcnt(5)
    s_nop 0
    v_mfma_f32_16x16x32_bf16 v[100:103], v[92:95], v[56:59], v[100:103]
    s_waitcnt lgkmcnt(4)
    v_mfma_f32_16x16x32_bf16 v[104:107], v[92:95], v[60:63], v[104:107]
    v_perm_b32 v88, v27, v27, v80
    v_perm_b32 v89, v27, v27, v81
    v_perm_b32 v90, v27, v27, v82
    v_perm_b32 v91, v27, v27, v83
    s_waitcnt lgkmcnt(3)
    s_nop 0
    v_mfma_f32_16x16x32_bf16 v[100:103], v[88:91], v[64:67], v[100:103]
    s_waitcnt lgkmcnt(2)
    v_mfma_f32_16x16x32_bf16 v[104:107], v[88:91], v[68:71], v[104:107]
    v_perm_b32 v92, v27, v27, v84
    v_perm_b32 v93, v27, v27, v85
    v_perm_b32 v94, v27, v27, v86
    v_perm_b32 v95, v27, v27, v87
    s_waitcnt lgkmcnt(1)
    s_nop 0
    v_mfma_f32_16x16x32_bf16 v[100:103], v[92:95], v[72:75], v[100:103]
    s_waitcnt lgkmcnt(0)
    ds_write_b32 v15, v5 offset:16
    v_mfma_f32_16x16x32_bf16 v[104:107], v[92:95], v[76:79], v[104:107]
    s_add_u32 s67, s78, 1792
    buffer_load_dwordx4 a[104:107], v111, s[60:63], s67 offen offset:768
    s_add_u32 s67, s78, 8960
    buffer_load_dwordx4 a[60:63], v111, s[60:63], s67 offen offset:0
    buffer_load_dwordx4 a[68:71], v111, s[60:63], s67 offen offset:128
    buffer_load_dwordx4 a[76:79], v111, s[60:63], s67 offen offset:256
L_wob_95:
    s_add_u32 s67, s23, 88
    s_cmp_gt_i32 s65, s67
    s_cbranch_scc1 L_wtok_97
L_wt_96:
    ds_read_b32 v4, v1 offset:0
    s_waitcnt lgkmcnt(0)
    v_readfirstlane_b32 s65, v4
    s_nop 0
    s_cmp_gt_i32 s65, s67
    s_cbranch_scc1 L_wtok_97
    s_sub_u32 s66, s66, 1
    s_cbranch_scc1 L_end
    s_branch L_wt_96
L_wtok_97:
    ds_read_b128 v[48:51], v109 offset:0
    ds_read_b128 v[52:55], v109 offset:256
    ds_read_b128 v[56:59], v109 offset:512
    ds_read_b128 v[60:63], v109 offset:768
    ds_read_b128 v[64:67], v109 offset:1024
    ds_read_b128 v[68:71], v109 offset:1280
    ds_read_b128 v[72:75], v109 offset:1536
    ds_read_b128 v[76:79], v109 offset:1792
    v_mov_b32 v5, 23
    v_perm_b32 v88, v28, v28, v80
    v_perm_b32 v89, v28, v28, v81
    v_perm_b32 v90, v28, v28, v82
    v_perm_b32 v91, v28, v28, v83
    s_waitcnt lgkmcnt(7)
    s_nop 0
    v_mfma_f32_16x16x32_bf16 v[100:103], v[88:91], v[48:51], v[100:103]
    s_waitcnt lgkmcnt(6)
    v_mfma_f32_16x16x32_bf16 v[104:107], v[88:91], v[52:55], v[104:107]
    v_perm_b32 v92, v28, v28, v84
    v_perm_b32 v93, v28, v28, v85
    v_perm_b32 v94, v28, v28, v86
    v_perm_b32 v95, v28, v28, v87
    s_waitcnt lgkmcnt(5)
    s_nop 0
    v_mfma_f32_16x16x32_bf16 v[100:103], v[92:95], v[56:59], v[100:103]
    s_waitcnt lgkmcnt(4)
    v_mfma_f32_16x16x32_bf16 v[104:107], v[92:95], v[60:63], v[104:107]
    v_perm_b32 v88, v29, v29, v80
    v_perm_b32 v89, v29, v29, v81
    v_perm_b32 v90, v29, v29, v82
    v_perm_b32 v91, v29, v29, v83
    s_waitcnt lgkmcnt(3)
    s_nop 0
    v_mfma_f32_16x16x32_bf16 v[100:103], v[88:91], v[64:67], v[100:103]
    s_waitcnt lgkmcnt(2)
    v_mfma_f32_16x16x32_bf16 v[104:107], v[88:91], v[68:71], v[104:107]
    v_perm_b32 v92, v29, v29, v84
    v_perm_b32 v93, v29, v29, v85
    v_perm_b32 v94, v29, v29, v86
    v_perm_b32 v95, v29, v29, v87
    s_waitcnt lgkmcnt(1)
    s_nop 0
    v_mfma_f32_16x16x32_bf16 v[100:103], v[92:95], v[72:75], v[100:103]
    s_waitcnt lgkmcnt(0)
    ds_write_b32 v15, v5 offset:16
    v_mfma_f32_16x16x32_bf16 v[104:107], v[92:95], v[76:79], v[104:107]
    s_add_u32 s67, s78, 8960
    buffer_load_dwordx4 a[84:87], v111, s[60:63], s67 offen offset:384
    buffer_load_dwordx4 a[92:95], v111, s[60:63], s67 offen offset:512
    buffer_load_dwordx4 a[100:103], v111, s[60:63], s67 offen offset:640
    buffer_load_dwordx4 a[108:111], v111, s[60:63], s67 offen offset:768
L_wob_98:
    s_add_u32 s67, s23, 92
    s_cmp_gt_i32 s65, s67
    s_cbranch_scc1 L_wtok_100
L_wt_99:
    ds_read_b32 v4, v1 offset:0
    s_waitcnt lgkmcnt(0)
    v_readfirstlane_b32 s65, v4
    s_nop 0
    s_cmp_gt_i32 s65, s67
    s_cbranch_scc1 L_wtok_100
    s_sub_u32 s66, s66, 1
    s_cbranch_scc1 L_end
    s_branch L_wt_99
L_wtok_100:
    ds_read_b128 v[48:51], v109 offset:32768
    ds_read_b128 v[52:55], v109 offset:33024
    ds_read_b128 v[56:59], v109 offset:33280
    ds_read_b128 v[60:63], v109 offset:33536
    ds_read_b128 v[64:67], v109 offset:33792
    ds_read_b128 v[68:71], v109 offset:34048
    ds_read_b128 v[72:75], v109 offset:34304
    ds_read_b128 v[76:79], v109 offset:34560
    v_mov_b32 v5, 24
    v_perm_b32 v88, v30, v30, v80
    v_perm_b32 v89, v30, v30, v81
    v_perm_b32 v90, v30, v30, v82
    v_perm_b32 v91, v30, v30, v83
    s_waitcnt lgkmcnt(7)
    s_nop 0
    v_mfma_f32_16x16x32_bf16 v[100:103], v[88:91], v[48:51], v[100:103]
    s_waitcnt lgkmcnt(6)
    v_mfma_f32_16x16x32_bf16 v[104:107], v[88:91], v[52:55], v[104:107]
    v_perm_b32 v92, v30, v30, v84
    v_perm_b32 v93, v30, v30, v85
    v_perm_b32 v94, v30, v30, v86
    v_perm_b32 v95, v30, v30, v87
    s_waitcnt lgkmcnt(5)
    s_nop 0
    v_mfma_f32_16x16x32_bf16 v[100:103], v[92:95], v[56:59], v[100:103]
    s_waitcnt lgkmcnt(4)
    v_mfma_f32_16x16x32_bf16 v[104:107], v[92:95], v[60:63], v[104:107]
    v_perm_b32 v88, v31, v31, v80
    v_perm_b32 v89, v31, v31, v81
    v_perm_b32 v90, v31, v31, v82
    v_perm_b32 v91, v31, v31, v83
    s_waitcnt lgkmcnt(3)
    s_nop 0
    v_mfma_f32_16x16x32_bf16 v[100:103], v[88:91], v[64:67], v[100:103]
    s_waitcnt lgkmcnt(2)
    v_mfma_f32_16x16x32_bf16 v[104:107], v[88:91], v[68:71], v[104:107]
    v_perm_b32 v92, v31, v31, v84
    v_perm_b32 v93, v31, v31, v85
    v_perm_b32 v94, v31, v31, v86
    v_perm_b32 v95, v31, v31, v87
    s_waitcnt lgkmcnt(1)
    s_nop 0
    v_mfma_f32_16x16x32_bf16 v[100:103], v[92:95], v[72:75], v[100:103]
    s_waitcnt lgkmcnt(0)
    ds_write_b32 v15, v5 offset:16
    v_mfma_f32_16x16x32_bf16 v[104:107], v[92:95], v[76:79], v[104:107]
    s_add_u32 s67, s23, 96
    s_cmp_gt_i32 s65, s67
    s_cbranch_scc1 L_wtok_102
L_wt_101:
    ds_read_b32 v4, v1 offset:0
    s_waitcnt lgkmcnt(0)
    v_readfirstlane_b32 s65, v4
    s_nop 0
    s_cmp_gt_i32 s65, s67
    s_cbranch_scc1 L_wtok_102
    s_sub_u32 s66, s66, 1
    s_cbranch_scc1 L_end
    s_branch L_wt_101
L_wtok_102:
    ds_read_b128 v[48:51], v108 offset:0
    ds_read_b128 v[52:55], v108 offset:256
    ds_read_b128 v[56:59], v108 offset:512
    ds_read_b128 v[60:63], v108 offset:768
    ds_read_b128 v[64:67], v108 offset:1024
    ds_read_b128 v[68:71], v108 offset:1280
    ds_read_b128 v[72:75], v108 offset:1536
    ds_read_b128 v[76:79], v108 offset:1792
    v_mov_b32 v5, 25
    v_perm_b32 v88, v32, v32, v80
    v_perm_b32 v89, v32, v32, v81
    v_perm_b32 v90, v32, v32, v82
    v_perm_b32 v91, v32, v32, v83
    s_waitcnt lgkmcnt(7)
    s_nop 0
    v_mfma_f32_16x16x32_bf16 v[100:103], v[88:91], v[48:51], v[100:103]
    s_waitcnt lgkmcnt(6)
    v_mfma_f32_16x16x32_bf16 v[104:107], v[88:91], v[52:55], v[104:107]
    v_perm_b32 v92, v32, v32, v84
    v_perm_b32 v93, v32, v32, v85
    v_perm_b32 v94, v32, v32, v86
    v_perm_b32 v95, v32, v32, v87
    s_waitcnt lgkmcnt(5)
    s_nop 0
    v_mfma_f32_16x16x32_bf16 v[100:103], v[92:95], v[56:59], v[100:103]
    s_waitcnt lgkmcnt(4)
    v_mfma_f32_16x16x32_bf16 v[104:107], v[92:95], v[60:63], v[104:107]
    v_perm_b32 v88, v33, v33, v80
    v_perm_b32 v89, v33, v33, v81
    v_perm_b32 v90, v33, v33, v82
    v_perm_b32 v91, v33, v33, v83
    s_waitcnt lgkmcnt(3)
    s_nop 0
    v_mfma_f32_16x16x32_bf16 v[100:103], v[88:91], v[64:67], v[100:103]
    s_waitcnt lgkmcnt(2)
    v_mfma_f32_16x16x32_bf16 v[104:107], v[88:91], v[68:71], v[104:107]
    v_perm_b32 v92, v33, v33, v84
    v_perm_b32 v93, v33, v33, v85
    v_perm_b32 v94, v33, v33, v86
    v_perm_b32 v95, v33, v33, v87
    s_waitcnt lgkmcnt(1)
    s_nop 0
    v_mfma_f32_16x16x32_bf16 v[100:103], v[92:95], v[72:75], v[100:103]
    s_waitcnt lgkmcnt(0)
    ds_write_b32 v15, v5 offset:16
    v_mfma_f32_16x16x32_bf16 v[104:107], v[92:95], v[76:79], v[104:107]
    s_add_u32 s67, s23, 100
    s_cmp_gt_i32 s65, s67
    s_cbranch_scc1 L_wtok_104
L_wt_103:
    ds_read_b32 v4, v1 offset:0
    s_waitcnt lgkmcnt(0)
    v_readfirstlane_b32 s65, v4
    s_nop 0
    s_cmp_gt_i32 s65, s67
    s_cbranch_scc1 L_wtok_104
    s_sub_u32 s66, s66, 1
    s_cbranch_scc1 L_end
    s_branch L_wt_103
L_wtok_104:
    ds_read_b128 v[48:51], v108 offset:32768
    ds_read_b128 v[52:55], v108 offset:33024
    ds_read_b128 v[56:59], v108 offset:33280
    ds_read_b128 v[60:63], v108 offset:33536
    ds_read_b128 v[64:67], v108 offset:33792
    ds_read_b128 v[68:71], v108 offset:34048
    ds_read_b128 v[72:75], v108 offset:34304
    ds_read_b128 v[76:79], v108 offset:34560
    v_mov_b32 v5, 26
    v_perm_b32 v88, v34, v34, v80
    v_perm_b32 v89, v34, v34, v81
    v_perm_b32 v90, v34, v34, v82
    v_perm_b32 v91, v34, v34, v83
    s_waitcnt lgkmcnt(7)
    s_nop 0
    v_mfma_f32_16x16x32_bf16 v[100:103], v[88:91], v[48:51], v[100:103]
    s_waitcnt lgkmcnt(6)
    v_mfma_f32_16x16x32_bf16 v[104:107], v[88:91], v[52:55], v[104:107]
    v_perm_b32 v92, v34, v34, v84
    v_perm_b32 v93, v34, v34, v85
    v_perm_b32 v94, v34, v34, v86
    v_perm_b32 v95, v34, v34, v87
    s_waitcnt lgkmcnt(5)
    s_nop 0
    v_mfma_f32_16x16x32_bf16 v[100:103], v[92:95], v[56:59], v[100:103]
    s_waitcnt lgkmcnt(4)
    v_mfma_f32_16x16x32_bf16 v[104:107], v[92:95], v[60:63], v[104:107]
    v_perm_b32 v88, v35, v35, v80
    v_perm_b32 v89, v35, v35, v81
    v_perm_b32 v90, v35, v35, v82
    v_perm_b32 v91, v35, v35, v83
    s_waitcnt lgkmcnt(3)
    s_nop 0
    v_mfma_f32_16x16x32_bf16 v[100:103], v[88:91], v[64:67], v[100:103]
    s_waitcnt lgkmcnt(2)
    v_mfma_f32_16x16x32_bf16 v[104:107], v[88:91], v[68:71], v[104:107]
    v_perm_b32 v92, v35, v35, v84
    v_perm_b32 v93, v35, v35, v85
    v_perm_b32 v94, v35, v35, v86
    v_perm_b32 v95, v35, v35, v87
    s_waitcnt lgkmcnt(1)
    s_nop 0
    v_mfma_f32_16x16x32_bf16 v[100:103], v[92:95], v[72:75], v[100:103]
    s_waitcnt lgkmcnt(0)
    ds_write_b32 v15, v5 offset:16
    v_mfma_f32_16x16x32_bf16 v[104:107], v[92:95], v[76:79], v[104:107]
    s_add_u32 s67, s23, 104
    s_cmp_gt_i32 s65, s67
    s_cbranch_scc1 L_wtok_106
L_wt_105:
    ds_read_b32 v4, v1 offset:0
    s_waitcnt lgkmcnt(0)
    v_readfirstlane_b32 s65, v4
    s_nop 0
    s_cmp_gt_i32 s65, s67
    s_cbranch_scc1 L_wtok_106
    s_sub_u32 s66, s66, 1
    s_cbranch_scc1 L_end
    s_branch L_wt_105
L_wtok_106:
    ds_read_b128 v[48:51], v109 offset:0
    ds_read_b128 v[52:55], v109 offset:256
    ds_read_b128 v[56:59], v109 offset:512
    ds_read_b128 v[60:63], v109 offset:768
    ds_read_b128 v[64:67], v109 offset:1024
    ds_read_b128 v[68:71], v109 offset:1280
    ds_read_b128 v[72:75], v109 offset:1536
    ds_read_b128 v[76:79], v109 offset:1792
    v_mov_b32 v5, 27
    v_perm_b32 v88, v36, v36, v80
    v_perm_b32 v89, v36, v36, v81
    v_perm_b32 v90, v36, v36, v82
    v_perm_b32 v91, v36, v36, v83
    s_waitcnt lgkmcnt(7)
    s_nop 0
    v_mfma_f32_16x16x32_bf16 v[100:103], v[88:91], v[48:51], v[100:103]
    s_waitcnt lgkmcnt(6)
    v_mfma_f32_16x16x32_bf16 v[104:107], v[88:91], v[52:55], v[104:107]
    v_perm_b32 v92, v36, v36, v84
    v_perm_b32 v93, v36, v36, v85
    v_perm_b32 v94, v36, v36, v86
    v_perm_b32 v95, v36, v36, v87
    s_waitcnt lgkmcnt(5)
    s_nop 0
    v_mfma_f32_16x16x32_bf16 v[100:103], v[92:95], v[56:59], v[100:103]
    s_waitcnt lgkmcnt(4)
    v_mfma_f32_16x16x32_bf16 v[104:107], v[92:95], v[60:63], v[104:107]
    v_perm_b32 v88, v37, v37, v80
    v_perm_b32 v89, v37, v37, v81
    v_perm_b32 v90, v37, v37, v82
    v_perm_b32 v91, v37, v37, v83
    s_waitcnt lgkmcnt(3)
    s_nop 0
    v_mfma_f32_16x16x32_bf16 v[100:103], v[88:91], v[64:67], v[100:103]
    s_waitcnt lgkmcnt(2)
    v_mfma_f32_16x16x32_bf16 v[104:107], v[88:91], v[68:71], v[104:107]
    v_perm_b32 v92, v37, v37, v84
    v_perm_b32 v93, v37, v37, v85
    v_perm_b32 v94, v37, v37, v86
    v_perm_b32 v95, v37, v37, v87
    s_waitcnt lgkmcnt(1)
    s_nop 0
    v_mfma_f32_16x16x32_bf16 v[100:103], v[92:95], v[72:75], v[100:103]
    s_waitcnt lgkmcnt(0)
    ds_write_b32 v15, v5 offset:16
    v_mfma_f32_16x16x32_bf16 v[104:107], v[92:95], v[76:79], v[104:107]
    s_add_u32 s67, s23, 108
    s_cmp_gt_i32 s65, s67
    s_cbranch_scc1 L_wtok_108
L_wt_107:
    ds_read_b32 v4, v1 offset:0
    s_waitcnt lgkmcnt(0)
    v_readfirstlane_b32 s65, v4
    s_nop 0
    s_cmp_gt_i32 s65, s67
    s_cbranch_scc1 L_wtok_108
    s_sub_u32 s66, s66, 1
    s_cbranch_scc1 L_end
    s_branch L_wt_107
L_wtok_108:
    ds_read_b128 v[48:51], v109 offset:32768
    ds_read_b128 v[52:55], v109 offset:33024
    ds_read_b128 v[56:59], v109 offset:33280
    ds_read_b128 v[60:63], v109 offset:33536
    ds_read_b128 v[64:67], v109 offset:33792
    ds_read_b128 v[68:71], v109 offset:34048
    ds_read_b128 v[72:75], v109 offset:34304
    ds_read_b128 v[76:79], v109 offset:34560
    v_mov_b32 v5, 28
    v_perm_b32 v88, v38, v38, v80
    v_perm_b32 v89, v38, v38, v81
    v_perm_b32 v90, v38, v38, v82
    v_perm_b32 v91, v38, v38, v83
    s_waitcnt lgkmcnt(7)
    s_nop 0
    v_mfma_f32_16x16x32_bf16 v[100:103], v[88:91], v[48:51], v[100:103]
    s_waitcnt lgkmcnt(6)
    v_mfma_f32_16x16x32_bf16 v[104:107], v[88:91], v[52:55], v[104:107]
    v_perm_b32 v92, v38, v38, v84
    v_perm_b32 v93, v38, v38, v85
    v_perm_b32 v94, v38, v38, v86
    v_perm_b32 v95, v38, v38, v87
    s_waitcnt lgkmcnt(5)
    s_nop 0
    v_mfma_f32_16x16x32_bf16 v[100:103], v[92:95], v[56:59], v[100:103]
    s_waitcnt lgkmcnt(4)
    v_mfma_f32_16x16x32_bf16 v[104:107], v[92:95], v[60:63], v[104:107]
    v_perm_b32 v88, v39, v39, v80
    v_perm_b32 v89, v39, v39, v81
    v_perm_b32 v90, v39, v39, v82
    v_perm_b32 v91, v39, v39, v83
    s_waitcnt lgkmcnt(3)
    s_nop 0
    v_mfma_f32_16x16x32_bf16 v[100:103], v[88:91], v[64:67], v[100:103]
    s_waitcnt lgkmcnt(2)
    v_mfma_f32_16x16x32_bf16 v[104:107], v[88:91], v[68:71], v[104:107]
    v_perm_b32 v92, v39, v39, v84
    v_perm_b32 v93, v39, v39, v85
    v_perm_b32 v94, v39, v39, v86
    v_perm_b32 v95, v39, v39, v87
    s_waitcnt lgkmcnt(1)
    s_nop 0
    v_mfma_f32_16x16x32_bf16 v[100:103], v[92:95], v[72:75], v[100:103]
    s_waitcnt lgkmcnt(0)
    ds_write_b32 v15, v5 offset:16
    v_mfma_f32_16x16x32_bf16 v[104:107], v[92:95], v[76:79], v[104:107]
    s_add_u32 s67, s23, 112
    s_cmp_gt_i32 s65, s67
    s_cbranch_scc1 L_wtok_110
L_wt_109:
    ds_read_b32 v4, v1 offset:0
    s_waitcnt lgkmcnt(0)
    v_readfirstlane_b32 s65, v4
    s_nop 0
    s_cmp_gt_i32 s65, s67
    s_cbranch_scc1 L_wtok_110
    s_sub_u32 s66, s66, 1
    s_cbranch_scc1 L_end
    s_branch L_wt_109
L_wtok_110:
    ds_read_b128 v[48:51], v108 offset:0
    ds_read_b128 v[52:55], v108 offset:256
    ds_read_b128 v[56:59], v108 offset:512
    ds_read_b128 v[60:63], v108 offset:768
    ds_read_b128 v[64:67], v108 offset:1024
    ds_read_b128 v[68:71], v108 offset:1280
    ds_read_b128 v[72:75], v108 offset:1536
    ds_read_b128 v[76:79], v108 offset:1792
    v_mov_b32 v5, 29
    v_perm_b32 v88, v40, v40, v80
    v_perm_b32 v89, v40, v40, v81
    v_perm_b32 v90, v40, v40, v82
    v_perm_b32 v91, v40, v40, v83
    s_waitcnt lgkmcnt(7)
    s_nop 0
    v_mfma_f32_16x16x32_bf16 v[100:103], v[88:91], v[48:51], v[100:103]
    s_waitcnt lgkmcnt(6)
    v_mfma_f32_16x16x32_bf16 v[104:107], v[88:91], v[52:55], v[104:107]
    v_perm_b32 v92, v40, v40, v84
    v_perm_b32 v93, v40, v40, v85
    v_perm_b32 v94, v40, v40, v86
    v_perm_b32 v95, v40, v40, v87
    s_waitcnt lgkmcnt(5)
    s_nop 0
    v_mfma_f32_16x16x32_bf16 v[100:103], v[92:95], v[56:59], v[100:103]
    s_waitcnt lgkmcnt(4)
    v_mfma_f32_16x16x32_bf16 v[104:107], v[92:95], v[60:63], v[104:107]
    v_perm_b32 v88, v41, v41, v80
    v_perm_b32 v89, v41, v41, v81
    v_perm_b32 v90, v41, v41, v82
    v_perm_b32 v91, v41, v41, v83
    s_waitcnt lgkmcnt(3)
    s_nop 0
    v_mfma_f32_16x16x32_bf16 v[100:103], v[88:91], v[64:67], v[100:103]
    s_waitcnt lgkmcnt(2)
    v_mfma_f32_16x16x32_bf16 v[104:107], v[88:91], v[68:71], v[104:107]
    v_perm_b32 v92, v41, v41, v84
    v_perm_b32 v93, v41, v41, v85
    v_perm_b32 v94, v41, v41, v86
    v_perm_b32 v95, v41, v41, v87
    s_waitcnt lgkmcnt(1)
    s_nop 0
    v_mfma_f32_16x16x32_bf16 v[100:103], v[92:95], v[72:75], v[100:103]
    s_waitcnt lgkmcnt(0)
    ds_write_b32 v15, v5 offset:16
    v_mfma_f32_16x16x32_bf16 v[104:107], v[92:95], v[76:79], v[104:107]
    v_lshrrev_b32 v10, 5, v0
    v_and_b32 v11, 15, v0
    v_lshlrev_b32 v10, 10, v10
    v_lshl_add_u32 v10, v11, 5, v10
    v_bfe_u32 v11, v0, 4, 1
    v_lshl_add_u32 v18, v11, 4, v10
    v_mov_b32 v13, 0x1000000
    v_lshlrev_b32 v10, 4, v0
    v_add_u32 v16, 133120, v10
    s_lshl_b32 s68, s74, 11
    s_add_u32 s68, s68, 262144
    v_and_b32 v10, 3, v0
    v_bfe_u32 v11, v0, 3, 1
    v_lshl_add_u32 v10, v10, 1, v11
    v_lshrrev_b32 v11, 4, v0
    v_lshlrev_b32 v10, 10, v10
    v_lshl_add_u32 v19, v11, 4, v10
    s_lshl_b32 s69, s73, 13
    s_lshl2_add_u32 s67, s101, s23
    s_lshl_b32 s67, s67, 6
    s_add_u32 s69, s69, s67
    s_add_u32 s69, s69, 262144
    v_lshrrev_b32 v10, 5, v0
    s_lshl_b32 s67, s23, 1
    v_add_u32 v10, s67, v10
    v_mul_u32_u24 v10, 1824, v10
    v_and_b32 v11, 7, v0
    v_lshl_add_u32 v10, v11, 5, v10
    v_bfe_u32 v11, v0, 4, 1
    v_lshl_add_u32 v10, v11, 4, v10
    v_add_u32 v20, 139264, v10
    v_lshrrev_b32 v10, 1, v0
    v_min_u32 v10, 27, v10
    s_mul_i32 s67, s23, 28
    v_add_u32 v10, s67, v10
    v_lshlrev_b32 v10, 4, v10
    v_and_b32 v11, 1, v0
    v_mul_u32_u24 v12, 7296, v11
    v_add3_u32 v21, v10, v12, v1
    v_add_u32 v21, 8192, v21
    v_cmp_gt_u32 vcc, 56, v0
    s_nop 1
    v_cndmask_b32 v10, v13, v10, vcc
    v_cmp_eq_u32 vcc, 0, v11
    s_nop 1
    v_cndmask_b32 v22, v13, v10, vcc
    s_lshl_b32 s76, s74, 11
    s_add_u32 s76, s76, 786432
    s_lshl_b32 s67, s23, 2
    s_add_u32 s67, s67, 131328
    v_mov_b32 v23, s67
    v_lshrrev_b32 v10, 3, v0
    v_lshlrev_b32 v10, 3, v10
    v_add_u32 v24, 153856, v10
    v_lshrrev_b32 v10, 4, v0
    v_bfe_u32 v11, v0, 3, 1
    v_and_b32 v12, 1, v10
    v_lshl_add_u32 v11, v12, 1, v11
    v_xor_b32 v11, s23, v11
    v_lshlrev_b32 v11, 5, v11
    v_lshl_add_u32 v11, v10, 10, v11
    v_bfe_u32 v12, v0, 2, 2
    v_lshl_add_u32 v11, v12, 7, v11
    v_and_b32 v12, 3, v0
    v_lshl_add_u32 v29, v12, 3, v11
    v_lshrrev_b32 v11, 5, v0
    v_bfe_u32 v12, v0, 4, 1
    v_lshlrev_b32 v11, 6, v11
    v_lshl_add_u32 v11, v12, 5, v11
    v_bfe_u32 v12, v0, 3, 1
    v_lshl_add_u32 v11, v12, 3, v11
    v_add_u32 v30, 154240, v11
    v_bfe_u32 v10, v0, 2, 1
    v_cmp_eq_u32 vcc, 0, v10
    v_mov_b32 v11, 0xffff
    s_nop 0
    v_cndmask_b32 v40, 0, v11, vcc
    v_cndmask_b32 v41, v11, 0, vcc
    v_and_b32 v10, 3, v0
    v_add_u32 v11, 1, v10
    v_and_b32 v11, 3, v11
    v_lshl_add_u32 v10, v11, 2, v10
    v_mul_u32_u24 v42, 0x1111, v10
    s_mul_i32 s34, s64, 0x3d2f1b65
    s_mov_b32 s8, 0x07060500
    s_mov_b32 s9, 0x07060501
    s_mov_b32 s10, 0x07060502
    s_mov_b32 s11, 0x07060503
    s_mov_b32 s12, 0x0c0c0400
    s_mov_b32 s13, 0x04000c0c
    v_mov_b32 v25, s34
L_wf_111:
    ds_read_b32 v4, v1 offset:192
    s_waitcnt lgkmcnt(0)
    v_readfirstlane_b32 s67, v4
    s_nop 0
    s_cmp_lg_u32 s67, 0
    s_cbranch_scc1 L_wfok_112
    s_sub_u32 s66, s66, 1
    s_cbranch_scc1 L_end
    s_branch L_wf_111
L_wfok_112:
    v_lshrrev_b32 v10, 5, v0
    v_lshl_add_u32 v10, v10, 2, v1
    ds_read_b32 v11, v10 offset:196
    v_bfe_u32 v10, v0, 3, 1
    v_lshl_add_u32 v10, v10, 2, v1
    ds_read_b32 v2, v10 offset:204
    s_add_u32 s72, s23, 116
    s_waitcnt vmcnt(0) lgkmcnt(0)
    v_mul_f32 v100, v100, v11
    v_mul_f32 v101, v101, v11
    v_mul_f32 v102, v102, v11
    v_mul_f32 v103, v103, v11
    v_mul_f32 v104, v104, v11
    v_mul_f32 v105, v105, v11
    v_mul_f32 v106, v106, v11
    v_mul_f32 v107, v107, v11
L_pool:
    ds_read_b32 v4, v23
    ds_read_b32 v5, v1 offset:0
    s_waitcnt lgkmcnt(0)
    v_readfirstlane_b32 s24, v4
    v_readfirstlane_b32 s65, v5
    s_cmp_gt_u32 s24, 24
    s_cbranch_scc1 L_pool_end
    s_cmp_gt_i32 s65, s72
    s_cbranch_scc1 L_pool_go
    s_sub_u32 s66, s66, 1
    s_cbranch_scc1 L_end
    s_branch L_pool
L_pool_go:
    s_cmp_eq_u32 s24, 0
    s_cbranch_scc1 L_pool
    s_sub_u32 s24, s24, 1
    s_bfe_u32 s25, s24, 0x20001
    s_lshl_b32 s25, s25, 11
    s_and_b32 s67, s24, 1
    s_lshr_b32 s24, s24, 3
    s_lshl1_add_u32 s24, s24, s67
    s_lshl_b32 s24, s24, 6
    s_add_u32 s24, s24, s25
    s_and_b32 s25, s72, 12
    s_lshl_b32 s25, s25, 13
    v_add_u32 v4, s24, v24
    v_add_u32 v28, s25, v108
    ds_read_b64 v[26:27], v4
    ds_read_b128 v[48:51], v28 offset:0
    ds_read_b128 v[52:55], v28 offset:256
    ds_read_b128 v[56:59], v28 offset:512
    ds_read_b128 v[60:63], v28 offset:768
    ds_read_b128 v[64:67], v28 offset:1024
    ds_read_b128 v[68:71], v28 offset:1280
    ds_read_b128 v[72:75], v28 offset:1536
    ds_read_b128 v[76:79], v28 offset:1792
    s_lshr_b32 s25, s72, 2
    s_add_u32 s25, s25, 1
    v_mov_b32 v5, s25
    v_add_u32 v23, 16, v23
    s_add_u32 s72, s72, 4
    s_waitcnt lgkmcnt(8)
    v_perm_b32 v88, v26, v26, v80
    v_perm_b32 v89, v26, v26, v81
    v_perm_b32 v90, v26, v26, v82
    v_perm_b32 v91, v26, v26, v83
    s_waitcnt lgkmcnt(7)
    s_nop 0
    v_mfma_f32_16x16x32_bf16 v[100:103], v[88:91], v[48:51], v[100:103]
    s_waitcnt lgkmcnt(6)
    v_mfma_f32_16x16x32_bf16 v[104:107], v[88:91], v[52:55], v[104:107]
    v_perm_b32 v92, v26, v26, v84
    v_perm_b32 v93, v26, v26, v85
    v_perm_b32 v94, v26, v26, v86
    v_perm_b32 v95, v26, v26, v87
    s_waitcnt lgkmcnt(5)
    s_nop 0
    v_mfma_f32_16x16x32_bf16 v[100:103], v[92:95], v[56:59], v[100:103]
    s_waitcnt lgkmcnt(4)
    v_mfma_f32_16x16x32_bf16 v[104:107], v[92:95], v[60:63], v[104:107]
    v_perm_b32 v88, v27, v27, v80
    v_perm_b32 v89, v27, v27, v81
    v_perm_b32 v90, v27, v27, v82
    v_perm_b32 v91, v27, v27, v83
    s_waitcnt lgkmcnt(3)
    s_nop 0
    v_mfma_f32_16x16x32_bf16 v[100:103], v[88:91], v[64:67], v[100:103]
    s_waitcnt lgkmcnt(2)
    v_mfma_f32_16x16x32_bf16 v[104:107], v[88:91], v[68:71], v[104:107]
    v_perm_b32 v92, v27, v27, v84
    v_perm_b32 v93, v27, v27, v85
    v_perm_b32 v94, v27, v27, v86
    v_perm_b32 v95, v27, v27, v87
    s_waitcnt lgkmcnt(1)
    s_nop 0
    v_mfma_f32_16x16x32_bf16 v[100:103], v[92:95], v[72:75], v[100:103]
    s_waitcnt lgkmcnt(0)
    ds_write_b32 v15, v5 offset:16
    v_mfma_f32_16x16x32_bf16 v[104:107], v[92:95], v[76:79], v[104:107]
    s_branch L_pool
L_pool_end:
    s_sub_u32 s25, s23, s24
    s_and_b32 s25, s25, 3
    s_cmp_eq_u32 s25, 3
    s_cbranch_scc1 L_collect
    s_lshl_b32 s67, s25, 11
    v_add_u32 v17, s67, v16
    s_lshl_b32 s67, s25, 2
    v_add_u32 v4, s67, v1
    ds_write_b128 v17, v[100:103]
    ds_write_b128 v17, v[104:107] offset:1024
    ds_write_b32 v4, v14 offset:112
    s_branch L_collected
L_collect:
L_collect_rt:
    ds_read_b128 v[4:7], v1 offset:112
    ds_read_b128 v[48:51], v16 offset:0
    ds_read_b128 v[52:55], v16 offset:1024
    ds_read_b128 v[56:59], v16 offset:2048
    ds_read_b128 v[60:63], v16 offset:3072
    ds_read_b128 v[64:67], v16 offset:4096
    ds_read_b128 v[68:71], v16 offset:5120
    s_sub_u32 s66, s66, 1
    s_cbranch_scc1 L_end
    s_waitcnt lgkmcnt(6)
    v_min3_u32 v4, v4, v5, v6
    v_cmp_eq_u32 vcc, 0, v4
    s_cbranch_vccz L_collect_ok
    s_waitcnt lgkmcnt(0)
    s_branch L_collect_rt
L_collect_ok:
    s_waitcnt lgkmcnt(5)
    v_pk_add_f32 v[100:101], v[100:101], v[48:49]
    v_pk_add_f32 v[102:103], v[102:103], v[50:51]
    s_waitcnt lgkmcnt(4)
    v_pk_add_f32 v[104:105], v[104:105], v[52:53]
    v_pk_add_f32 v[106:107], v[106:107], v[54:55]
    s_waitcnt lgkmcnt(3)
    v_pk_add_f32 v[100:101], v[100:101], v[56:57]
    v_pk_add_f32 v[102:103], v[102:103], v[58:59]
    s_waitcnt lgkmcnt(2)
    v_pk_add_f32 v[104:105], v[104:105], v[60:61]
    v_pk_add_f32 v[106:107], v[106:107], v[62:63]
    s_waitcnt lgkmcnt(1)
    v_pk_add_f32 v[100:101], v[100:101], v[64:65]
    v_pk_add_f32 v[102:103], v[102:103], v[66:67]
    v_perm_b32 v100, v100, v25, s8
    v_perm_b32 v101, v101, v25, s9
    v_perm_b32 v102, v102, v25, s10
    v_perm_b32 v103, v103, v25, s11
    buffer_store_dwordx4 v[100:103], v18, s[52:55], s68 offen offset:0 sc1
    s_waitcnt lgkmcnt(0)
    v_pk_add_f32 v[104:105], v[104:105], v[68:69]
    v_pk_add_f32 v[106:107], v[106:107], v[70:71]
    v_perm_b32 v104, v104, v25, s8
    v_perm_b32 v105, v105, v25, s9
    v_perm_b32 v106, v106, v25, s10
    v_perm_b32 v107, v107, v25, s11
    buffer_store_dwordx4 v[104:107], v18, s[52:55], s68 offen offset:512 sc1
L_collected:
    s_mov_b32 s72, s23
    s_mov_b32 s23, s24
    s_add_u32 s67, s23, 0
    s_cmp_gt_i32 s65, s67
    s_cbranch_scc1 L_wtok_114
L_wt_113:
    ds_read_b32 v4, v1 offset:0
    s_waitcnt lgkmcnt(0)
    v_readfirstlane_b32 s65, v4
    s_nop 0
    s_cmp_gt_i32 s65, s67
    s_cbranch_scc1 L_wtok_114
    s_sub_u32 s66, s66, 1
    s_cbranch_scc1 L_end
    s_branch L_wt_113
L_wtok_114:
    s_add_u32 s25, s23, 0
    s_and_b32 s25, s25, 15
    s_lshl_b32 s25, s25, 13
    v_add_u32 v28, s25, v29
    v_add_u32 v4, 0, v30
    ds_read2_b64 v[64:67], v4 offset0:0 offset1:2
    ds_read_b64_tr_b16 v[48:49], v28 offset:0
    ds_read_b64_tr_b16 v[50:51], v28 offset:512
    v_add_u32 v5, 128, v30
    ds_read2_b64 v[68:71], v5 offset0:0 offset1:2
    ds_read_b64_tr_b16 v[52:53], v28 offset:4096
    ds_read_b64_tr_b16 v[54:55], v28 offset:4608
    s_waitcnt lgkmcnt(3)
    v_mfma_f32_16x16x32_bf16 v[32:35], v[48:51], v[64:67], 0
    s_waitcnt lgkmcnt(0)
    v_mfma_f32_16x16x32_bf16 v[32:35], v[52:55], v[68:71], v[32:35]
    s_add_u32 s67, s23, 1
    s_cmp_gt_i32 s65, s67
    s_cbranch_scc1 L_wtok_116
L_wt_115:
    ds_read_b32 v4, v1 offset:0
    s_waitcnt lgkmcnt(0)
    v_readfirstlane_b32 s65, v4
    s_nop 0
    s_cmp_gt_i32 s65, s67
    s_cbranch_scc1 L_wtok_116
    s_sub_u32 s66, s66, 1
    s_cbranch_scc1 L_end
    s_branch L_wt_115
L_wtok_116:
    s_add_u32 s25, s23, 1
    s_and_b32 s25, s25, 15
    s_lshl_b32 s25, s25, 13
    v_add_u32 v28, s25, v29
    v_add_u32 v4, 2048, v30
    ds_read2_b64 v[64:67], v4 offset0:0 offset1:2
    ds_read_b64_tr_b16 v[48:49], v28 offset:0
    ds_read_b64_tr_b16 v[50:51], v28 offset:512
    v_add_u32 v5, 2176, v30
    ds_read2_b64 v[68:71], v5 offset0:0 offset1:2
    ds_read_b64_tr_b16 v[52:53], v28 offset:4096
    ds_read_b64_tr_b16 v[54:55], v28 offset:4608
    s_waitcnt lgkmcnt(3)
    v_mfma_f32_16x16x32_bf16 v[32:35], v[48:51], v[64:67], v[32:35]
    s_waitcnt lgkmcnt(0)
    v_mfma_f32_16x16x32_bf16 v[32:35], v[52:55], v[68:71], v[32:35]
    s_add_u32 s67, s23, 2
    s_cmp_gt_i32 s65, s67
    s_cbranch_scc1 L_wtok_118
L_wt_117:
    ds_read_b32 v4, v1 offset:0
    s_waitcnt lgkmcnt(0)
    v_readfirstlane_b32 s65, v4
    s_nop 0
    s_cmp_gt_i32 s65, s67
    s_cbranch_scc1 L_wtok_118
    s_sub_u32 s66, s66, 1
    s_cbranch_scc1 L_end
    s_branch L_wt_117
L_wtok_118:
    s_add_u32 s25, s23, 2
    s_and_b32 s25, s25, 15
    s_lshl_b32 s25, s25, 13
    v_add_u32 v28, s25, v29
    v_add_u32 v4, 4096, v30
    ds_read2_b64 v[64:67], v4 offset0:0 offset1:2
    ds_read_b64_tr_b16 v[48:49], v28 offset:0
    ds_read_b64_tr_b16 v[50:51], v28 offset:512
    v_add_u32 v5, 4224, v30
    ds_read2_b64 v[68:71], v5 offset0:0 offset1:2
    ds_read_b64_tr_b16 v[52:53], v28 offset:4096
    ds_read_b64_tr_b16 v[54:55], v28 offset:4608
    s_waitcnt lgkmcnt(3)
    v_mfma_f32_16x16x32_bf16 v[32:35], v[48:51], v[64:67], v[32:35]
    s_waitcnt lgkmcnt(0)
    v_mfma_f32_16x16x32_bf16 v[32:35], v[52:55], v[68:71], v[32:35]
    s_add_u32 s67, s23, 3
    s_cmp_gt_i32 s65, s67
    s_cbranch_scc1 L_wtok_120
L_wt_119:
    ds_read_b32 v4, v1 offset:0
    s_waitcnt lgkmcnt(0)
    v_readfirstlane_b32 s65, v4
    s_nop 0
    s_cmp_gt_i32 s65, s67
    s_cbranch_scc1 L_wtok_120
    s_sub_u32 s66, s66, 1
    s_cbranch_scc1 L_end
    s_branch L_wt_119
L_wtok_120:
    s_add_u32 s25, s23, 3
    s_and_b32 s25, s25, 15
    s_lshl_b32 s25, s25, 13
    v_add_u32 v28, s25, v29
    v_add_u32 v4, 6144, v30
    ds_read2_b64 v[64:67], v4 offset0:0 offset1:2
    ds_read_b64_tr_b16 v[48:49], v28 offset:0
    ds_read_b64_tr_b16 v[50:51], v28 offset:512
    v_add_u32 v5, 6272, v30
    ds_read2_b64 v[68:71], v5 offset0:0 offset1:2
    ds_read_b64_tr_b16 v[52:53], v28 offset:4096
    ds_read_b64_tr_b16 v[54:55], v28 offset:4608
    buffer_load_dwordx4 v[36:39], v19, s[52:55], s69 offen sc1
    s_waitcnt lgkmcnt(3)
    v_mfma_f32_16x16x32_bf16 v[32:35], v[48:51], v[64:67], v[32:35]
    s_waitcnt lgkmcnt(0)
    v_mfma_f32_16x16x32_bf16 v[32:35], v[52:55], v[68:71], v[32:35]
    s_add_u32 s67, s23, 4
    s_cmp_gt_i32 s65, s67
    s_cbranch_scc1 L_wtok_122
L_wt_121:
    ds_read_b32 v4, v1 offset:0
    s_waitcnt lgkmcnt(0)
    v_readfirstlane_b32 s65, v4
    s_nop 0
    s_cmp_gt_i32 s65, s67
    s_cbranch_scc1 L_wtok_122
    s_sub_u32 s66, s66, 1
    s_cbranch_scc1 L_end
    s_branch L_wt_121
L_wtok_122:
    s_add_u32 s25, s23, 4
    s_and_b32 s25, s25, 15
    s_lshl_b32 s25, s25, 13
    v_add_u32 v28, s25, v29
    v_add_u32 v4, 256, v30
    ds_read2_b64 v[64:67], v4 offset0:0 offset1:2
    ds_read_b64_tr_b16 v[48:49], v28 offset:0
    ds_read_b64_tr_b16 v[50:51], v28 offset:512
    v_add_u32 v5, 2304, v30
    ds_read2_b64 v[68:71], v5 offset0:0 offset1:2
    ds_read_b64_tr_b16 v[52:53], v28 offset:4096
    ds_read_b64_tr_b16 v[54:55], v28 offset:4608
    s_waitcnt lgkmcnt(3)
    v_mfma_f32_16x16x32_bf16 v[32:35], v[48:51], v[64:67], v[32:35]
    s_waitcnt lgkmcnt(0)
    v_mfma_f32_16x16x32_bf16 v[32:35], v[52:55], v[68:71], v[32:35]
    s_add_u32 s67, s23, 5
    s_cmp_gt_i32 s65, s67
    s_cbranch_scc1 L_wtok_124
L_wt_123:
    ds_read_b32 v4, v1 offset:0
    s_waitcnt lgkmcnt(0)
    v_readfirstlane_b32 s65, v4
    s_nop 0
    s_cmp_gt_i32 s65, s67
    s_cbranch_scc1 L_wtok_124
    s_sub_u32 s66, s66, 1
    s_cbranch_scc1 L_end
    s_branch L_wt_123
L_wtok_124:
    s_add_u32 s25, s23, 5
    s_and_b32 s25, s25, 15
    s_lshl_b32 s25, s25, 13
    v_add_u32 v28, s25, v29
    v_add_u32 v4, 4352, v30
    ds_read2_b64 v[64:67], v4 offset0:0 offset1:2
    ds_read_b64_tr_b16 v[48:49], v28 offset:0
    ds_read_b64_tr_b16 v[50:51], v28 offset:512
    v_add_u32 v5, 6400, v30
    ds_read2_b64 v[68:71], v5 offset0:0 offset1:2
    ds_read_b64_tr_b16 v[52:53], v28 offset:4096
    ds_read_b64_tr_b16 v[54:55], v28 offset:4608
    s_waitcnt lgkmcnt(3)
    v_mfma_f32_16x16x32_bf16 v[32:35], v[48:51], v[64:67], v[32:35]
    s_waitcnt lgkmcnt(0)
    v_mfma_f32_16x16x32_bf16 v[32:35], v[52:55], v[68:71], v[32:35]
    s_mov_b32 s23, s72
    s_branch L_hop1_chk
L_hop1:
    s_mov_b64 exec, vcc
    buffer_load_dwordx4 v[36:39], v19, s[52:55], s69 offen sc1
    s_mov_b64 exec, -1
    s_sub_u32 s66, s66, 1
    s_cbranch_scc1 L_end
L_hop1_chk:
    s_waitcnt vmcnt(0)
    v_perm_b32 v8, v37, v36, s12
    v_perm_b32 v9, v39, v38, s13
    v_or_b32 v8, v8, v9
    v_cmp_ne_u32 vcc, s34, v8
    s_cbranch_vccnz L_hop1
L_hop1_ok:
    v_add_f32_dpp v4, v36, v36 quad_perm:[1,0,3,2] row_mask:0xf bank_mask:0xf
    v_add_f32_dpp v5, v37, v37 quad_perm:[1,0,3,2] row_mask:0xf bank_mask:0xf
    v_add_f32_dpp v6, v38, v38 quad_perm:[1,0,3,2] row_mask:0xf bank_mask:0xf
    v_add_f32_dpp v7, v39, v39 quad_perm:[1,0,3,2] row_mask:0xf bank_mask:0xf
    v_add_f32_dpp v4, v4, v4 quad_perm:[2,3,0,1] row_mask:0xf bank_mask:0xf
    v_add_f32_dpp v5, v5, v5 quad_perm:[2,3,0,1] row_mask:0xf bank_mask:0xf
    v_add_f32_dpp v6, v6, v6 quad_perm:[2,3,0,1] row_mask:0xf bank_mask:0xf
    v_add_f32_dpp v7, v7, v7 quad_perm:[2,3,0,1] row_mask:0xf bank_mask:0xf
    v_add_f32 v4, v4, v32
    v_add_f32 v5, v5, v33
    v_add_f32 v6, v6, v34
    v_add_f32 v7, v7, v35
    v_mul_f32 v4, v4, v2
    v_mul_f32 v5, v5, v2
    v_mul_f32 v6, v6, v2
    v_mul_f32 v7, v7, v2
    v_cvt_pk_bf16_f32 v4, v4, v5
    v_cvt_pk_bf16_f32 v6, v6, v7
    v_and_b32 v88, v4, v40
    v_and_b32 v89, v4, v41
    v_lshrrev_b32 v4, 16, v4
    v_and_b32 v90, v4, v40
    v_and_b32 v91, v4, v41
    s_nop 1
    v_smfmac_f32_16x16x64_bf16 a[112:115], v[88:91], a[0:7], v42
    v_and_b32 v92, v6, v40
    v_and_b32 v93, v6, v41
    v_lshrrev_b32 v6, 16, v6
    v_and_b32 v94, v6, v40
    v_and_b32 v95, v6, v41
    s_mov_b32 s24, 0x00ff00ff
    s_mov_b32 s25, 0xff00ff00
    v_smfmac_f32_16x16x64_bf16 a[112:115], v[92:95], a[56:63], v42
    v_smfmac_f32_16x16x64_bf16 a[116:119], v[88:91], a[8:15], v42
    v_smfmac_f32_16x16x64_bf16 a[116:119], v[92:95], a[64:71], v42
    v_smfmac_f32_16x16x64_bf16 a[120:123], v[88:91], a[16:23], v42
    v_smfmac_f32_16x16x64_bf16 a[120:123], v[92:95], a[72:79], v42
    v_smfmac_f32_16x16x64_bf16 a[124:127], v[88:91], a[24:31], v42
    v_smfmac_f32_16x16x64_bf16 a[124:127], v[92:95], a[80:87], v42
    s_mov_b64 exec, s[24:25]
    s_nop 4
    ds_write_b128 v20, a[112:115] offset:0
    s_mov_b64 exec, -1
    v_smfmac_f32_16x16x64_bf16 a[128:131], v[88:91], a[32:39], v42
    v_smfmac_f32_16x16x64_bf16 a[128:131], v[92:95], a[88:95], v42
    s_mov_b64 exec, s[24:25]
    ds_write_b128 v20, a[116:119] offset:256
    s_mov_b64 exec, -1
    v_smfmac_f32_16x16x64_bf16 a[132:135], v[88:91], a[40:47], v42
    v_smfmac_f32_16x16x64_bf16 a[132:135], v[92:95], a[96:103], v42
    s_mov_b64 exec, s[24:25]
    ds_write_b128 v20, a[120:123] offset:512
    s_mov_b64 exec, -1
    v_smfmac_f32_16x16x64_bf16 a[136:139], v[88:91], a[48:55], v42
    v_smfmac_f32_16x16x64_bf16 a[136:139], v[92:95], a[104:111], v42
    s_mov_b64 exec, s[24:25]
    ds_write_b128 v20, a[124:127] offset:768
    s_mov_b64 exec, -1
    s_mov_b64 exec, s[24:25]
    ds_write_b128 v20, a[128:131] offset:1024
    s_nop 1
    ds_write_b128 v20, a[132:135] offset:1280
    s_nop 3
    ds_write_b128 v20, a[136:139] offset:1536
    s_mov_b64 exec, -1
    s_waitcnt lgkmcnt(0)
    s_barrier
    ds_read_b128 v[48:51], v21 offset:0
    ds_read_b128 v[52:55], v21 offset:1824
    ds_read_b128 v[56:59], v21 offset:3648
    ds_read_b128 v[60:63], v21 offset:5472
    s_waitcnt lgkmcnt(2)
    v_pk_add_f32 v[4:5], v[48:49], v[52:53]
    v_pk_add_f32 v[6:7], v[50:51], v[54:55]
    s_waitcnt lgkmcnt(1)
    v_pk_add_f32 v[4:5], v[4:5], v[56:57]
    v_pk_add_f32 v[6:7], v[6:7], v[58:59]
    s_waitcnt lgkmcnt(0)
    v_pk_add_f32 v[4:5], v[4:5], v[60:61]
    v_pk_add_f32 v[6:7], v[6:7], v[62:63]
    s_nop 0
    v_add_f32_dpp v4, v4, v4 quad_perm:[1,0,3,2] row_mask:0xf bank_mask:0xf
    v_add_f32_dpp v5, v5, v5 quad_perm:[1,0,3,2] row_mask:0xf bank_mask:0xf
    v_add_f32_dpp v6, v6, v6 quad_perm:[1,0,3,2] row_mask:0xf bank_mask:0xf
    v_add_f32_dpp v7, v7, v7 quad_perm:[1,0,3,2] row_mask:0xf bank_mask:0xf
    v_perm_b32 v4, v4, v25, s8
    v_perm_b32 v5, v5, v25, s9
    v_perm_b32 v6, v6, v25, s10
    v_perm_b32 v7, v7, v25, s11
    buffer_store_dwordx4 v[4:7], v22, s[52:55], s76 offen sc1
L_end:
    s_endpgm
.section .rodata,"a"
.p2align 6
.amdhsa_kernel parallel_sum__gqa_block_cached__mixer_channel_mlp__decode_kernel
  .amdhsa_next_free_vgpr 256
  .amdhsa_next_free_sgpr 102
  .amdhsa_accum_offset 112
  .amdhsa_group_segment_fixed_size 0
  .amdhsa_kernarg_size 104
  .amdhsa_user_sgpr_count 2
  .amdhsa_user_sgpr_kernarg_segment_ptr 1
  .amdhsa_system_sgpr_workgroup_id_x 1
  .amdhsa_float_denorm_mode_32 3
.end_amdhsa_kernel
```
